```python
import torch

def _softmax(x, axis=-1):
    return torch.softmax(x, dim=axis)
def _gelu(x):
    return torch.nn.functional.gelu(x, approximate="tanh")
def _silu(x):
    return torch.nn.functional.silu(x)
def _sigmoid(x):
    return torch.sigmoid(x)
def _layernorm(x, axis=-1, eps=1e-5):
    m = x.mean(dim=axis, keepdim=True)
    v = x.var(dim=axis, keepdim=True, unbiased=False)
    return (x - m) / torch.sqrt(v + eps)
def _scatter_add(tgt, idx, src, axis=0):
    return tgt.clone().index_add_(axis, idx, src)
def _segment_sum(src, seg, n):
    out = torch.zeros((n,) + src.shape[1:], dtype=src.dtype)
    return out.index_add_(0, seg, src)
def _pad(x, pw):
    flat = tuple(v for pair in reversed(pw) for v in pair)
    return torch.nn.functional.pad(x, flat)

kernel_name = 'parallel_sum__mha_block_cached__mixer_token_mlp__decode'

def setup_inputs():

    _w = (lambda a: (lambda t: t.to(torch.bfloat16) if t.is_floating_point() else t)(torch.as_tensor(a)))
    def _A_setup():
        B, Sq, D = 1, 1, 512
        H, Sk, Dh = 32, 32768, 128
        return {
            "x": _w((lambda *s: torch.randn(*s, dtype=torch.bfloat16) * 0.05)(B, Sq, D)),
            "k_cache": _w((lambda *s: torch.randn(*s, dtype=torch.bfloat16) * 3.2)(B, H, Sk, Dh)),
            "v_cache": _w((lambda *s: torch.randn(*s, dtype=torch.bfloat16) * 0.8)(B, H, Sk, Dh)),
            "wq": _w((lambda *s: torch.randn(*s, dtype=torch.bfloat16) * 3.2)(D, H * Dh) * (D ** -0.5)),
            "wo": _w((lambda *s: torch.randn(*s, dtype=torch.bfloat16) * 0.8)(H * Dh, D) * ((H * Dh) ** -0.5)),
        }
    _A_in = _A_setup()

    def _B_setup():
        B, S, D, F = 1, 1, 512, 1792
        return {
            "x": _w((lambda *s: torch.randn(*s, dtype=torch.bfloat16) * 0.05)(B, S, D)),
            "w1": _w((lambda *s: torch.randn(*s, dtype=torch.bfloat16) * 3.2)(S, F) * (S ** -0.5)),
            "b1": _w((lambda *s: torch.randn(*s, dtype=torch.bfloat16) * 3.2)(F) * 0.02),
            "w2": _w((lambda *s: torch.randn(*s, dtype=torch.bfloat16) * 0.4)(F, S) * (F ** -0.5)),
            "b2": _w((lambda *s: torch.randn(*s, dtype=torch.bfloat16) * 0.4)(S) * 0.02),
        }
    _B_in = _B_setup()

    return {
        "A_x": _A_in["x"],
        "A_k_cache": _A_in["k_cache"],
        "A_v_cache": _A_in["v_cache"],
        "A_wq": _A_in["wq"],
        "A_wo": _A_in["wo"],
        "B_x": _B_in["x"],
        "B_w1": _B_in["w1"],
        "B_b1": _B_in["b1"],
        "B_w2": _B_in["w2"],
        "B_b2": _B_in["b2"],
    }

def reference(A_x, A_k_cache, A_v_cache, A_wq, A_wo, B_x, B_w1, B_b1, B_w2, B_b2):
    def _A_ref(x, k_cache, v_cache, wq, wo):
        B, Sq, D = x.shape
        H, Dh = 32, 128
        q = (lambda x, *d: x.permute(*d))((x @ wq).reshape(B, Sq, H, Dh), 0, 2, 1, 3)
        scores = torch.einsum("bhqd,bhkd->bhqk", q, k_cache) * (Dh ** -0.5)
        p = _softmax(scores, axis=-1)
        o = torch.einsum("bhqk,bhkd->bhqd", p, v_cache)
        return (lambda x, *d: x.permute(*d))(o, 0, 2, 1, 3).reshape(B, Sq, H * Dh) @ wo

    def _B_ref(x, w1, b1, w2, b2):
        B, S, D = x.shape
        h = _layernorm(x, axis=-1)
        u = torch.einsum("bsd,sf->bdf", h, w1) + b1
        u = _gelu(u)
        y = torch.einsum("bdf,fs->bds", u, w2) + b2
        return (lambda x, *d: x.permute(*d))(y, 0, 2, 1)

    x = A_x
    xn = _layernorm(x, axis=-1)
    return x + _A_ref(xn, A_k_cache, A_v_cache, A_wq, A_wo) + _B_ref(xn, B_w1, B_b1, B_w2, B_b2)
```

```asm
; @launch grid=(256,1,1) block=(256,1,1) lds=77824
.amdgcn_target "amdgcn-amd-amdhsa--gfx950"
.text
.globl parallel_sum__mha_block_cached__mixer_token_mlp__decode_kernel
.p2align 8
.type parallel_sum__mha_block_cached__mixer_token_mlp__decode_kernel,@function
parallel_sum__mha_block_cached__mixer_token_mlp__decode_kernel:
    s_cmp_ge_u32 s2, 256
    s_cbranch_scc1 L_done
    s_load_dwordx16 s[76:91], s[0:1], 0
    s_load_dwordx8 s[92:99], s[0:1], 64
    s_load_dwordx2 s[44:45], s[0:1], 96
    v_lshrrev_b32 v32, 6, v0
    v_and_b32 v77, 63, v0
    v_readfirstlane_b32 s3, v32
    v_lshlrev_b32 v1, 4, v77
    s_and_b32 s50, s2, 31
    s_lshr_b32 s51, s2, 5
    s_lshl_b32 s52, s50, 3
    s_add_u32 s52, s52, s51
    s_lshl_b32 s58, s52, 20
    s_mul_i32 s53, s3, 4096
    s_mov_b32 s71, s53
    s_bfe_u32 s100, s2, 0x30003
    s_lshl_b32 s100, s100, 16
    s_mov_b32 s10, 1048576
    s_mov_b32 s11, 0x20000
    s_mov_b32 s18, 4194304
    s_mov_b32 s19, 0x20000
    s_mov_b32 s6, 1024
    s_mov_b32 s7, 0x20000
    v_lshrrev_b32 v34, 4, v77
    v_and_b32 v32, 0xf0, v1
    v_lshl_add_u32 v2, v34, 18, v32
    v_lshl_add_u32 v3, v34, 15, v32
    s_lshl_b32 s14, s3, 20
    s_lshl_b32 s59, s50, 8
    s_add_u32 s14, s14, s59
    s_mov_b32 s15, 0
    s_waitcnt lgkmcnt(0)
    s_mov_b64 s[4:5], s[76:77]
    s_add_u32 s8, s78, s58
    s_addc_u32 s9, s79, 0
    buffer_load_dwordx4 v[56:59], v1, s[4:7], 0 offen
    s_add_u32 s12, s80, s58
    s_addc_u32 s13, s81, 0
    s_mov_b64 s[16:17], s[82:83]
    s_xor_b32 s101, s53, s100
    buffer_load_dwordx4 v[96:99], v1, s[8:11], s101 offen nt
    s_add_u32 s53, s53, 1024
    s_xor_b32 s101, s53, s100
    buffer_load_dwordx4 v[100:103], v1, s[8:11], s101 offen nt
    s_add_u32 s53, s53, 1024
    s_xor_b32 s101, s53, s100
    buffer_load_dwordx4 v[104:107], v1, s[8:11], s101 offen nt
    s_add_u32 s53, s53, 1024
    s_xor_b32 s101, s53, s100
    buffer_load_dwordx4 v[108:111], v1, s[8:11], s101 offen nt
    s_add_u32 s53, s53, 13312
    s_xor_b32 s101, s53, s100
    buffer_load_dwordx4 v[112:115], v1, s[8:11], s101 offen nt
    s_add_u32 s53, s53, 1024
    s_xor_b32 s101, s53, s100
    buffer_load_dwordx4 v[116:119], v1, s[8:11], s101 offen nt
    s_add_u32 s53, s53, 1024
    s_load_dword s55, s[44:45], 0
    s_mov_b64 s[24:25], s[88:89]
    s_mov_b32 s26, 3584
    s_mov_b32 s27, 0x20000
    s_mov_b64 s[28:29], s[90:91]
    s_mov_b32 s30, 3584
    s_mov_b32 s31, 0x20000
    s_mov_b64 s[32:33], s[92:93]
    s_mov_b32 s34, 3584
    s_mov_b32 s35, 0x20000
    s_mov_b64 s[36:37], s[94:95]
    s_mov_b32 s38, 2
    s_mov_b32 s39, 0x20000
    s_mov_b64 s[20:21], s[84:85]
    s_mov_b32 s22, 4194304
    s_mov_b32 s23, 0x20000
    s_mov_b64 s[40:41], s[96:97]
    s_mov_b32 s42, 1024
    s_mov_b32 s43, 0x20000
    s_mov_b32 s46, 763904
    s_mov_b32 s47, 0x20000
    v_lshlrev_b32 v32, 4, v0
    v_mov_b32 v33, 0
    buffer_load_dwordx4 v[60:63], v32, s[24:27], 0 offen
    buffer_load_dwordx4 v[64:67], v32, s[28:31], 0 offen
    buffer_load_ushort v72, v33, s[36:39], 0 offen
    buffer_load_dwordx4 v[68:71], v32, s[32:35], 0 offen
    s_add_u32 s56, s14, s15
    s_add_u32 s15, s15, 0x8000
    s_and_b32 s15, s15, 0x3ffff
    buffer_load_dwordx4 a[0:3], v2, s[16:19], s56 offen nt
    s_add_u32 s56, s56, 8192
    buffer_load_dwordx4 a[4:7], v2, s[16:19], s56 offen nt
    s_waitcnt vmcnt(11)
    s_xor_b32 s101, s53, s100
    buffer_load_dwordx4 v[120:123], v1, s[8:11], s101 offen nt
    s_add_u32 s53, s53, 1024
    s_add_u32 s56, s56, 8192
    buffer_load_dwordx4 a[8:11], v2, s[16:19], s56 offen nt
    s_waitcnt vmcnt(12)
    s_xor_b32 s101, s53, s100
    buffer_load_dwordx4 v[124:127], v1, s[8:11], s101 offen nt
    s_add_u32 s53, s53, 13312
    s_add_u32 s56, s56, 8192
    buffer_load_dwordx4 a[12:15], v2, s[16:19], s56 offen nt
    s_waitcnt vmcnt(13)
    s_xor_b32 s101, s53, s100
    buffer_load_dwordx4 v[128:131], v1, s[8:11], s101 offen nt
    s_add_u32 s53, s53, 1024
    s_mov_b32 s66, 0xffff0000
    s_mov_b32 s57, 0x3fb8aa3b
    v_and_b32 v32, 1, v77
    v_lshlrev_b32 v32, 4, v32
    v_mov_b32 v34, 0xffff
    v_lshlrev_b32 v34, v32, v34
    v_bfe_u32 v32, v77, 1, 2
    v_mov_b32 v33, 0x0c0c0c0c
    s_mov_b32 s58, 0x01000100
    s_mov_b32 s59, 0x03020302
    v_cmp_eq_u32 vcc, 0, v32
    s_nop 1
    v_cndmask_b32 v16, 0, v34, vcc
    v_cmp_eq_u32 vcc, 1, v32
    s_nop 1
    v_cndmask_b32 v17, 0, v34, vcc
    v_cmp_eq_u32 vcc, 2, v32
    s_nop 1
    v_cndmask_b32 v18, 0, v34, vcc
    v_cmp_eq_u32 vcc, 3, v32
    s_nop 1
    v_cndmask_b32 v19, 0, v34, vcc
    v_bfi_b32 v20, v16, s58, v33
    v_bfi_b32 v24, v16, s59, v33
    v_bfi_b32 v21, v17, s58, v33
    v_bfi_b32 v25, v17, s59, v33
    v_bfi_b32 v22, v18, s58, v33
    v_bfi_b32 v26, v18, s59, v33
    v_bfi_b32 v23, v19, s58, v33
    v_bfi_b32 v27, v19, s59, v33
    v_and_b32 v35, 15, v77
    v_lshlrev_b32 v35, 5, v35
    v_and_b32 v32, 16, v77
    v_add_u32 v35, v35, v32
    v_mov_b32 v28, 0xff800000
    v_mov_b32 v30, 0
    s_waitcnt vmcnt(17)
    v_lshlrev_b32 v80, 16, v56
    v_and_b32 v81, s66, v56
    v_lshlrev_b32 v82, 16, v57
    v_and_b32 v83, s66, v57
    v_lshlrev_b32 v84, 16, v58
    v_and_b32 v85, s66, v58
    v_lshlrev_b32 v86, 16, v59
    v_and_b32 v87, s66, v59
    v_add_f32 v88, v80, v81
    v_add_f32 v91, v82, v83
    v_add_f32 v88, v88, v91
    v_add_f32 v91, v84, v85
    v_add_f32 v88, v88, v91
    v_add_f32 v91, v86, v87
    v_add_f32 v88, v88, v91
    s_nop 1
    v_add_f32_dpp v88, v88, v88 row_ror:8 row_mask:0xf bank_mask:0xf
    s_nop 1
    v_add_f32_dpp v88, v88, v88 row_ror:4 row_mask:0xf bank_mask:0xf
    s_nop 1
    v_add_f32_dpp v88, v88, v88 row_ror:2 row_mask:0xf bank_mask:0xf
    s_nop 1
    v_add_f32_dpp v88, v88, v88 row_ror:1 row_mask:0xf bank_mask:0xf
    v_mov_b32 v91, v88
    s_nop 1
    v_permlane16_swap_b32 v88, v91
    v_add_f32 v88, v88, v91
    v_mov_b32 v91, v88
    s_nop 1
    v_permlane32_swap_b32 v88, v91
    v_add_f32 v88, v88, v91
    v_mul_f32 v88, 0x3b000000, v88
    v_sub_f32 v91, v80, v88
    v_mul_f32 v89, v91, v91
    v_sub_f32 v91, v81, v88
    v_fmac_f32 v89, v91, v91
    v_sub_f32 v91, v82, v88
    v_fmac_f32 v89, v91, v91
    v_sub_f32 v91, v83, v88
    v_fmac_f32 v89, v91, v91
    v_sub_f32 v91, v84, v88
    v_fmac_f32 v89, v91, v91
    v_sub_f32 v91, v85, v88
    v_fmac_f32 v89, v91, v91
    v_sub_f32 v91, v86, v88
    v_fmac_f32 v89, v91, v91
    v_sub_f32 v91, v87, v88
    v_fmac_f32 v89, v91, v91
    s_nop 1
    v_add_f32_dpp v89, v89, v89 row_ror:8 row_mask:0xf bank_mask:0xf
    s_nop 1
    v_add_f32_dpp v89, v89, v89 row_ror:4 row_mask:0xf bank_mask:0xf
    s_nop 1
    v_add_f32_dpp v89, v89, v89 row_ror:2 row_mask:0xf bank_mask:0xf
    s_nop 1
    v_add_f32_dpp v89, v89, v89 row_ror:1 row_mask:0xf bank_mask:0xf
    v_mov_b32 v91, v89
    s_nop 1
    v_permlane16_swap_b32 v89, v91
    v_add_f32 v89, v89, v91
    v_mov_b32 v91, v89
    s_nop 1
    v_permlane32_swap_b32 v89, v91
    v_add_f32 v89, v89, v91
    v_mul_f32 v89, 0x3b000000, v89
    v_cvt_pk_bf16_f32 v88, v88, v88
    v_lshlrev_b32 v88, 16, v88
    v_cvt_pk_bf16_f32 v89, v89, v89
    v_lshlrev_b32 v89, 16, v89
    v_add_f32 v89, 0x3727c5ac, v89
    v_cvt_pk_bf16_f32 v89, v89, v89
    v_lshlrev_b32 v89, 16, v89
    v_sqrt_f32 v89, v89
    s_nop 0
    v_cvt_pk_bf16_f32 v89, v89, v89
    v_lshlrev_b32 v89, 16, v89
    v_rcp_f32 v90, v89
    v_sub_f32 v80, v80, v88
    v_sub_f32 v81, v81, v88
    v_cvt_pk_bf16_f32 v91, v80, v81
    v_lshlrev_b32 v80, 16, v91
    v_and_b32 v81, s66, v91
    v_mul_f32 v91, v80, v90
    v_fma_f32 v80, -v91, v89, v80
    v_fma_f32 v80, v80, v90, v91
    v_mul_f32 v91, v81, v90
    v_fma_f32 v81, -v91, v89, v81
    v_fma_f32 v81, v81, v90, v91
    v_cvt_pk_bf16_f32 v56, v80, v81
    v_sub_f32 v82, v82, v88
    v_sub_f32 v83, v83, v88
    v_cvt_pk_bf16_f32 v91, v82, v83
    v_lshlrev_b32 v82, 16, v91
    v_and_b32 v83, s66, v91
    v_mul_f32 v91, v82, v90
    v_fma_f32 v82, -v91, v89, v82
    v_fma_f32 v82, v82, v90, v91
    v_mul_f32 v91, v83, v90
    v_fma_f32 v83, -v91, v89, v83
    v_fma_f32 v83, v83, v90, v91
    v_cvt_pk_bf16_f32 v57, v82, v83
    v_sub_f32 v84, v84, v88
    v_sub_f32 v85, v85, v88
    v_cvt_pk_bf16_f32 v91, v84, v85
    v_lshlrev_b32 v84, 16, v91
    v_and_b32 v85, s66, v91
    v_mul_f32 v91, v84, v90
    v_fma_f32 v84, -v91, v89, v84
    v_fma_f32 v84, v84, v90, v91
    v_mul_f32 v91, v85, v90
    v_fma_f32 v85, -v91, v89, v85
    v_fma_f32 v85, v85, v90, v91
    v_cvt_pk_bf16_f32 v58, v84, v85
    v_sub_f32 v86, v86, v88
    v_sub_f32 v87, v87, v88
    v_cvt_pk_bf16_f32 v91, v86, v87
    v_lshlrev_b32 v86, 16, v91
    v_and_b32 v87, s66, v91
    v_mul_f32 v91, v86, v90
    v_fma_f32 v86, -v91, v89, v86
    v_fma_f32 v86, v86, v90, v91
    v_mul_f32 v91, v87, v90
    v_fma_f32 v87, -v91, v89, v87
    v_fma_f32 v87, v87, v90, v91
    v_cvt_pk_bf16_f32 v59, v86, v87
    s_lshl_b32 s58, s3, 10
    v_add_u32 v32, s58, v1
    ds_write_b128 v32, v[56:59] offset:0
    s_mul_i32 s58, s3, 1280
    v_and_b32 v32, 0x30, v77
    v_lshlrev_b32 v32, 2, v32
    v_add_u32 v32, s58, v32
    v_mov_b32 v80, v32
    s_waitcnt lgkmcnt(0)
    ds_read_b128 v[40:43], v80 offset:0
    ds_read_b128 v[44:47], v80 offset:16
    ds_read_b128 v[48:51], v80 offset:32
    ds_read_b128 v[52:55], v80 offset:48
    s_add_u32 s56, s14, s15
    s_add_u32 s15, s15, 0x8000
    s_and_b32 s15, s15, 0x3ffff
    buffer_load_dwordx4 a[16:19], v2, s[16:19], s56 offen nt
    s_waitcnt vmcnt(14)
    s_xor_b32 s101, s53, s100
    buffer_load_dwordx4 v[132:135], v1, s[8:11], s101 offen nt
    s_add_u32 s53, s53, 1024
    s_add_u32 s56, s56, 8192
    buffer_load_dwordx4 a[20:23], v2, s[16:19], s56 offen nt
    s_waitcnt vmcnt(15)
    s_xor_b32 s101, s53, s100
    buffer_load_dwordx4 v[136:139], v1, s[8:11], s101 offen nt
    s_add_u32 s53, s53, 1024
    s_add_u32 s56, s56, 8192
    buffer_load_dwordx4 a[24:27], v2, s[16:19], s56 offen nt
    s_waitcnt vmcnt(16)
    s_xor_b32 s101, s53, s100
    buffer_load_dwordx4 v[140:143], v1, s[8:11], s101 offen nt
    s_add_u32 s53, s53, 13312
    s_add_u32 s56, s56, 8192
    buffer_load_dwordx4 a[28:31], v2, s[16:19], s56 offen nt
    s_waitcnt vmcnt(11)
    s_xor_b32 s101, s53, s100
    buffer_load_dwordx4 v[144:147], v1, s[8:11], s101 offen nt
    s_add_u32 s53, s53, 1024
    s_lshl_b32 s58, s52, 2
    s_lshl_b32 s59, s3, 10
    s_add_u32 s58, s58, s59
    v_mov_b32 v73, s58
    ds_read_b32 v74, v73 offset:0
    v_lshlrev_b32 v80, 16, v56
    v_and_b32 v81, s66, v56
    v_lshlrev_b32 v82, 16, v57
    v_and_b32 v83, s66, v57
    v_lshlrev_b32 v84, 16, v58
    v_and_b32 v85, s66, v58
    v_lshlrev_b32 v86, 16, v59
    v_and_b32 v87, s66, v59
    v_add_f32 v88, v80, v81
    v_add_f32 v91, v82, v83
    v_add_f32 v88, v88, v91
    v_add_f32 v91, v84, v85
    v_add_f32 v88, v88, v91
    v_add_f32 v91, v86, v87
    v_add_f32 v88, v88, v91
    s_nop 1
    v_add_f32_dpp v88, v88, v88 row_ror:8 row_mask:0xf bank_mask:0xf
    s_nop 1
    v_add_f32_dpp v88, v88, v88 row_ror:4 row_mask:0xf bank_mask:0xf
    s_nop 1
    v_add_f32_dpp v88, v88, v88 row_ror:2 row_mask:0xf bank_mask:0xf
    s_nop 1
    v_add_f32_dpp v88, v88, v88 row_ror:1 row_mask:0xf bank_mask:0xf
    v_mov_b32 v91, v88
    s_nop 1
    v_permlane16_swap_b32 v88, v91
    v_add_f32 v88, v88, v91
    v_mov_b32 v91, v88
    s_nop 1
    v_permlane32_swap_b32 v88, v91
    v_add_f32 v88, v88, v91
    v_mul_f32 v88, 0x3b000000, v88
    s_add_u32 s56, s14, s15
    s_add_u32 s15, s15, 0x8000
    s_and_b32 s15, s15, 0x3ffff
    buffer_load_dwordx4 a[32:35], v2, s[16:19], s56 offen nt
    s_waitcnt vmcnt(11)
    s_xor_b32 s101, s53, s100
    buffer_load_dwordx4 v[148:151], v1, s[8:11], s101 offen nt
    s_add_u32 s53, s53, 1024
    s_add_u32 s56, s56, 8192
    buffer_load_dwordx4 a[36:39], v2, s[16:19], s56 offen nt
    v_sub_f32 v91, v80, v88
    v_mul_f32 v89, v91, v91
    v_sub_f32 v91, v81, v88
    v_fmac_f32 v89, v91, v91
    v_sub_f32 v91, v82, v88
    v_fmac_f32 v89, v91, v91
    v_sub_f32 v91, v83, v88
    v_fmac_f32 v89, v91, v91
    v_sub_f32 v91, v84, v88
    v_fmac_f32 v89, v91, v91
    v_sub_f32 v91, v85, v88
    v_fmac_f32 v89, v91, v91
    v_sub_f32 v91, v86, v88
    v_fmac_f32 v89, v91, v91
    v_sub_f32 v91, v87, v88
    v_fmac_f32 v89, v91, v91
    s_nop 1
    v_add_f32_dpp v89, v89, v89 row_ror:8 row_mask:0xf bank_mask:0xf
    s_nop 1
    v_add_f32_dpp v89, v89, v89 row_ror:4 row_mask:0xf bank_mask:0xf
    s_nop 1
    v_add_f32_dpp v89, v89, v89 row_ror:2 row_mask:0xf bank_mask:0xf
    s_nop 1
    v_add_f32_dpp v89, v89, v89 row_ror:1 row_mask:0xf bank_mask:0xf
    v_mov_b32 v91, v89
    s_nop 1
    v_permlane16_swap_b32 v89, v91
    v_add_f32 v89, v89, v91
    v_mov_b32 v91, v89
    s_nop 1
    v_permlane32_swap_b32 v89, v91
    v_add_f32 v89, v89, v91
    v_mul_f32 v89, 0x3b000000, v89
    v_cvt_pk_bf16_f32 v88, v88, v88
    v_lshlrev_b32 v88, 16, v88
    v_cvt_pk_bf16_f32 v89, v89, v89
    v_lshlrev_b32 v89, 16, v89
    v_add_f32 v89, 0x3727c5ac, v89
    v_cvt_pk_bf16_f32 v89, v89, v89
    v_lshlrev_b32 v89, 16, v89
    v_sqrt_f32 v89, v89
    s_nop 0
    v_cvt_pk_bf16_f32 v89, v89, v89
    v_lshlrev_b32 v89, 16, v89
    v_rcp_f32 v90, v89
    s_waitcnt lgkmcnt(0)
    v_lshlrev_b32 v80, 16, v74
    v_and_b32 v81, s66, v74
    v_sub_f32 v80, v80, v88
    v_sub_f32 v81, v81, v88
    v_cvt_pk_bf16_f32 v91, v80, v81
    v_lshlrev_b32 v80, 16, v91
    v_and_b32 v81, s66, v91
    v_mul_f32 v91, v80, v90
    v_fma_f32 v80, -v91, v89, v80
    v_fma_f32 v80, v80, v90, v91
    v_mul_f32 v91, v81, v90
    v_fma_f32 v81, -v91, v89, v81
    v_fma_f32 v81, v81, v90, v91
    v_cvt_pk_bf16_f32 v74, v80, v81
    v_lshlrev_b32 v73, 16, v74
    v_and_b32 v74, s66, v74
    v_mov_b32 v75, 0
    v_mov_b32 v76, 0
    v_mov_b32 v88, 0xbdd2d3e8
    s_add_u32 s56, s56, 8192
    buffer_load_dwordx4 a[40:43], v2, s[16:19], s56 offen nt
    s_waitcnt vmcnt(12)
    s_xor_b32 s101, s53, s100
    buffer_load_dwordx4 v[152:155], v1, s[8:11], s101 offen nt
    s_add_u32 s53, s53, 1024
    s_add_u32 s56, s56, 8192
    buffer_load_dwordx4 a[44:47], v2, s[16:19], s56 offen nt
    s_waitcnt vmcnt(12)
    s_xor_b32 s101, s53, s100
    buffer_load_dwordx4 v[156:159], v1, s[8:11], s101 offen nt
    s_add_u32 s53, s53, 13312
    s_waitcnt vmcnt(22)
    v_lshlrev_b32 v80, 16, v60
    v_and_b32 v81, s66, v60
    v_lshlrev_b32 v82, 16, v64
    v_and_b32 v83, s66, v64
    v_mul_f32 v84, v73, v80
    v_mul_f32 v85, v73, v81
    v_cvt_pk_bf16_f32 v86, v84, v85
    v_lshlrev_b32 v84, 16, v86
    v_and_b32 v85, s66, v86
    v_add_f32 v84, v84, v82
    v_add_f32 v85, v85, v83
    v_cvt_pk_bf16_f32 v86, v84, v85
    v_lshlrev_b32 v84, 16, v86
    v_and_b32 v85, s66, v86
    v_mul_f32 v86, v84, v84
    v_mul_f32 v87, v85, v85
    v_fmaak_f32 v86, v86, v88, 0xc0135761
    v_fmaak_f32 v87, v87, v88, 0xc0135761
    v_mul_f32 v86, v86, v84
    v_mul_f32 v87, v87, v85
    v_exp_f32 v86, v86
    v_exp_f32 v87, v87
    v_add_f32 v86, 1.0, v86
    v_add_f32 v87, 1.0, v87
    v_rcp_f32 v86, v86
    v_rcp_f32 v87, v87
    v_mul_f32 v84, v84, v86
    v_mul_f32 v85, v85, v87
    v_cvt_pk_bf16_f32 v86, v84, v85
    v_dot2_f32_bf16 v75, v86, v68, v75
    s_add_u32 s56, s14, s15
    s_add_u32 s15, s15, 0x8000
    s_and_b32 s15, s15, 0x3ffff
    buffer_load_dwordx4 a[48:51], v2, s[16:19], s56 offen nt
    s_waitcnt vmcnt(12)
    s_xor_b32 s101, s53, s100
    buffer_load_dwordx4 v[160:163], v1, s[8:11], s101 offen nt
    s_add_u32 s53, s53, 1024
    s_add_u32 s56, s56, 8192
    buffer_load_dwordx4 a[52:55], v2, s[16:19], s56 offen nt
    s_waitcnt vmcnt(12)
    s_xor_b32 s101, s53, s100
    buffer_load_dwordx4 v[164:167], v1, s[8:11], s101 offen nt
    s_add_u32 s53, s53, 1024
    v_mul_f32 v84, v74, v80
    v_mul_f32 v85, v74, v81
    v_cvt_pk_bf16_f32 v86, v84, v85
    v_lshlrev_b32 v84, 16, v86
    v_and_b32 v85, s66, v86
    v_add_f32 v84, v84, v82
    v_add_f32 v85, v85, v83
    v_cvt_pk_bf16_f32 v86, v84, v85
    v_lshlrev_b32 v84, 16, v86
    v_and_b32 v85, s66, v86
    v_mul_f32 v86, v84, v84
    v_mul_f32 v87, v85, v85
    v_fmaak_f32 v86, v86, v88, 0xc0135761
    v_fmaak_f32 v87, v87, v88, 0xc0135761
    v_mul_f32 v86, v86, v84
    v_mul_f32 v87, v87, v85
    v_exp_f32 v86, v86
    v_exp_f32 v87, v87
    v_add_f32 v86, 1.0, v86
    v_add_f32 v87, 1.0, v87
    v_rcp_f32 v86, v86
    v_rcp_f32 v87, v87
    v_mul_f32 v84, v84, v86
    v_mul_f32 v85, v85, v87
    v_cvt_pk_bf16_f32 v86, v84, v85
    v_dot2_f32_bf16 v76, v86, v68, v76
    s_add_u32 s56, s56, 8192
    buffer_load_dwordx4 a[56:59], v2, s[16:19], s56 offen nt
    s_waitcnt vmcnt(12)
    s_xor_b32 s101, s53, s100
    buffer_load_dwordx4 v[168:171], v1, s[8:11], s101 offen nt
    s_add_u32 s53, s53, 1024
    s_add_u32 s56, s56, 8192
    buffer_load_dwordx4 a[60:63], v2, s[16:19], s56 offen nt
    s_waitcnt vmcnt(12)
    s_xor_b32 s101, s53, s100
    buffer_load_dwordx4 v[172:175], v1, s[8:11], s101 offen nt
    s_add_u32 s53, s53, 13312
    v_lshlrev_b32 v80, 16, v61
    v_and_b32 v81, s66, v61
    v_lshlrev_b32 v82, 16, v65
    v_and_b32 v83, s66, v65
    v_mul_f32 v84, v73, v80
    v_mul_f32 v85, v73, v81
    v_cvt_pk_bf16_f32 v86, v84, v85
    v_lshlrev_b32 v84, 16, v86
    v_and_b32 v85, s66, v86
    v_add_f32 v84, v84, v82
    v_add_f32 v85, v85, v83
    v_cvt_pk_bf16_f32 v86, v84, v85
    v_lshlrev_b32 v84, 16, v86
    v_and_b32 v85, s66, v86
    v_mul_f32 v86, v84, v84
    v_mul_f32 v87, v85, v85
    v_fmaak_f32 v86, v86, v88, 0xc0135761
    v_fmaak_f32 v87, v87, v88, 0xc0135761
    v_mul_f32 v86, v86, v84
    v_mul_f32 v87, v87, v85
    v_exp_f32 v86, v86
    v_exp_f32 v87, v87
    v_add_f32 v86, 1.0, v86
    v_add_f32 v87, 1.0, v87
    v_rcp_f32 v86, v86
    v_rcp_f32 v87, v87
    v_mul_f32 v84, v84, v86
    v_mul_f32 v85, v85, v87
    v_cvt_pk_bf16_f32 v86, v84, v85
    v_dot2_f32_bf16 v75, v86, v69, v75
    s_add_u32 s56, s14, s15
    s_add_u32 s15, s15, 0x8000
    s_and_b32 s15, s15, 0x3ffff
    buffer_load_dwordx4 a[64:67], v2, s[16:19], s56 offen nt
    s_waitcnt vmcnt(11)
    s_xor_b32 s101, s53, s100
    buffer_load_dwordx4 v[176:179], v1, s[8:11], s101 offen nt
    s_add_u32 s53, s53, 1024
    s_add_u32 s56, s56, 8192
    buffer_load_dwordx4 a[68:71], v2, s[16:19], s56 offen nt
    s_waitcnt vmcnt(11)
    s_xor_b32 s101, s53, s100
    buffer_load_dwordx4 v[180:183], v1, s[8:11], s101 offen nt
    s_add_u32 s53, s53, 1024
    v_mul_f32 v84, v74, v80
    v_mul_f32 v85, v74, v81
    v_cvt_pk_bf16_f32 v86, v84, v85
    v_lshlrev_b32 v84, 16, v86
    v_and_b32 v85, s66, v86
    v_add_f32 v84, v84, v82
    v_add_f32 v85, v85, v83
    v_cvt_pk_bf16_f32 v86, v84, v85
    v_lshlrev_b32 v84, 16, v86
    v_and_b32 v85, s66, v86
    v_mul_f32 v86, v84, v84
    v_mul_f32 v87, v85, v85
    v_fmaak_f32 v86, v86, v88, 0xc0135761
    v_fmaak_f32 v87, v87, v88, 0xc0135761
    v_mul_f32 v86, v86, v84
    v_mul_f32 v87, v87, v85
    v_exp_f32 v86, v86
    v_exp_f32 v87, v87
    v_add_f32 v86, 1.0, v86
    v_add_f32 v87, 1.0, v87
    v_rcp_f32 v86, v86
    v_rcp_f32 v87, v87
    v_mul_f32 v84, v84, v86
    v_mul_f32 v85, v85, v87
    v_cvt_pk_bf16_f32 v86, v84, v85
    v_dot2_f32_bf16 v76, v86, v69, v76
    s_add_u32 s56, s56, 8192
    buffer_load_dwordx4 a[72:75], v2, s[16:19], s56 offen nt
    s_waitcnt vmcnt(11)
    s_xor_b32 s101, s53, s100
    buffer_load_dwordx4 v[184:187], v1, s[8:11], s101 offen nt
    s_add_u32 s53, s53, 1024
    s_add_u32 s56, s56, 8192
    buffer_load_dwordx4 a[76:79], v2, s[16:19], s56 offen nt
    v_lshlrev_b32 v80, 16, v62
    v_and_b32 v81, s66, v62
    v_lshlrev_b32 v82, 16, v66
    v_and_b32 v83, s66, v66
    v_mul_f32 v84, v73, v80
    v_mul_f32 v85, v73, v81
    v_cvt_pk_bf16_f32 v86, v84, v85
    v_lshlrev_b32 v84, 16, v86
    v_and_b32 v85, s66, v86
    v_add_f32 v84, v84, v82
    v_add_f32 v85, v85, v83
    v_cvt_pk_bf16_f32 v86, v84, v85
    v_lshlrev_b32 v84, 16, v86
    v_and_b32 v85, s66, v86
    v_mul_f32 v86, v84, v84
    v_mul_f32 v87, v85, v85
    v_fmaak_f32 v86, v86, v88, 0xc0135761
    v_fmaak_f32 v87, v87, v88, 0xc0135761
    v_mul_f32 v86, v86, v84
    v_mul_f32 v87, v87, v85
    v_exp_f32 v86, v86
    v_exp_f32 v87, v87
    v_add_f32 v86, 1.0, v86
    v_add_f32 v87, 1.0, v87
    v_rcp_f32 v86, v86
    v_rcp_f32 v87, v87
    v_mul_f32 v84, v84, v86
    v_mul_f32 v85, v85, v87
    v_cvt_pk_bf16_f32 v86, v84, v85
    v_dot2_f32_bf16 v75, v86, v70, v75
    s_add_u32 s56, s14, s15
    s_add_u32 s15, s15, 0x8000
    s_and_b32 s15, s15, 0x3ffff
    buffer_load_dwordx4 a[80:83], v2, s[16:19], s56 offen nt
    s_waitcnt vmcnt(12)
    s_xor_b32 s101, s53, s100
    buffer_load_dwordx4 v[188:191], v1, s[8:11], s101 offen nt
    s_add_u32 s53, s53, 13312
    s_add_u32 s56, s56, 8192
    buffer_load_dwordx4 a[84:87], v2, s[16:19], s56 offen nt
    s_waitcnt vmcnt(12)
    s_xor_b32 s101, s53, s100
    buffer_load_dwordx4 v[192:195], v1, s[8:11], s101 offen nt
    s_add_u32 s53, s53, 1024
    v_mul_f32 v84, v74, v80
    v_mul_f32 v85, v74, v81
    v_cvt_pk_bf16_f32 v86, v84, v85
    v_lshlrev_b32 v84, 16, v86
    v_and_b32 v85, s66, v86
    v_add_f32 v84, v84, v82
    v_add_f32 v85, v85, v83
    v_cvt_pk_bf16_f32 v86, v84, v85
    v_lshlrev_b32 v84, 16, v86
    v_and_b32 v85, s66, v86
    v_mul_f32 v86, v84, v84
    v_mul_f32 v87, v85, v85
    v_fmaak_f32 v86, v86, v88, 0xc0135761
    v_fmaak_f32 v87, v87, v88, 0xc0135761
    v_mul_f32 v86, v86, v84
    v_mul_f32 v87, v87, v85
    v_exp_f32 v86, v86
    v_exp_f32 v87, v87
    v_add_f32 v86, 1.0, v86
    v_add_f32 v87, 1.0, v87
    v_rcp_f32 v86, v86
    v_rcp_f32 v87, v87
    v_mul_f32 v84, v84, v86
    v_mul_f32 v85, v85, v87
    v_cvt_pk_bf16_f32 v86, v84, v85
    v_dot2_f32_bf16 v76, v86, v70, v76
    s_add_u32 s56, s56, 8192
    buffer_load_dwordx4 a[88:91], v2, s[16:19], s56 offen nt
    s_waitcnt vmcnt(12)
    s_xor_b32 s101, s53, s100
    buffer_load_dwordx4 v[196:199], v1, s[8:11], s101 offen nt
    s_add_u32 s53, s53, 1024
    s_add_u32 s56, s56, 8192
    buffer_load_dwordx4 a[92:95], v2, s[16:19], s56 offen nt
    s_waitcnt vmcnt(12)
    s_xor_b32 s101, s53, s100
    buffer_load_dwordx4 v[200:203], v1, s[8:11], s101 offen nt
    s_add_u32 s53, s53, 1024
    v_lshlrev_b32 v80, 16, v63
    v_and_b32 v81, s66, v63
    v_lshlrev_b32 v82, 16, v67
    v_and_b32 v83, s66, v67
    v_mul_f32 v84, v73, v80
    v_mul_f32 v85, v73, v81
    v_cvt_pk_bf16_f32 v86, v84, v85
    v_lshlrev_b32 v84, 16, v86
    v_and_b32 v85, s66, v86
    v_add_f32 v84, v84, v82
    v_add_f32 v85, v85, v83
    v_cvt_pk_bf16_f32 v86, v84, v85
    v_lshlrev_b32 v84, 16, v86
    v_and_b32 v85, s66, v86
    v_mul_f32 v86, v84, v84
    v_mul_f32 v87, v85, v85
    v_fmaak_f32 v86, v86, v88, 0xc0135761
    v_fmaak_f32 v87, v87, v88, 0xc0135761
    v_mul_f32 v86, v86, v84
    v_mul_f32 v87, v87, v85
    v_exp_f32 v86, v86
    v_exp_f32 v87, v87
    v_add_f32 v86, 1.0, v86
    v_add_f32 v87, 1.0, v87
    v_rcp_f32 v86, v86
    v_rcp_f32 v87, v87
    v_mul_f32 v84, v84, v86
    v_mul_f32 v85, v85, v87
    v_cvt_pk_bf16_f32 v86, v84, v85
    v_dot2_f32_bf16 v75, v86, v71, v75
    s_add_u32 s56, s14, s15
    s_add_u32 s15, s15, 0x8000
    s_and_b32 s15, s15, 0x3ffff
    buffer_load_dwordx4 a[96:99], v2, s[16:19], s56 offen nt
    s_waitcnt vmcnt(12)
    s_xor_b32 s101, s53, s100
    buffer_load_dwordx4 v[204:207], v1, s[8:11], s101 offen nt
    s_add_u32 s53, s53, 13312
    s_add_u32 s56, s56, 8192
    buffer_load_dwordx4 a[100:103], v2, s[16:19], s56 offen nt
    s_waitcnt vmcnt(12)
    s_xor_b32 s101, s53, s100
    buffer_load_dwordx4 v[208:211], v1, s[8:11], s101 offen nt
    s_add_u32 s53, s53, 1024
    v_mul_f32 v84, v74, v80
    v_mul_f32 v85, v74, v81
    v_cvt_pk_bf16_f32 v86, v84, v85
    v_lshlrev_b32 v84, 16, v86
    v_and_b32 v85, s66, v86
    v_add_f32 v84, v84, v82
    v_add_f32 v85, v85, v83
    v_cvt_pk_bf16_f32 v86, v84, v85
    v_lshlrev_b32 v84, 16, v86
    v_and_b32 v85, s66, v86
    v_mul_f32 v86, v84, v84
    v_mul_f32 v87, v85, v85
    v_fmaak_f32 v86, v86, v88, 0xc0135761
    v_fmaak_f32 v87, v87, v88, 0xc0135761
    v_mul_f32 v86, v86, v84
    v_mul_f32 v87, v87, v85
    v_exp_f32 v86, v86
    v_exp_f32 v87, v87
    v_add_f32 v86, 1.0, v86
    v_add_f32 v87, 1.0, v87
    v_rcp_f32 v86, v86
    v_rcp_f32 v87, v87
    v_mul_f32 v84, v84, v86
    v_mul_f32 v85, v85, v87
    v_cvt_pk_bf16_f32 v86, v84, v85
    v_dot2_f32_bf16 v76, v86, v71, v76
    s_add_u32 s56, s56, 8192
    buffer_load_dwordx4 a[104:107], v2, s[16:19], s56 offen nt
    s_waitcnt vmcnt(11)
    s_xor_b32 s101, s53, s100
    buffer_load_dwordx4 v[212:215], v1, s[8:11], s101 offen nt
    s_add_u32 s53, s53, 1024
    s_add_u32 s56, s56, 8192
    buffer_load_dwordx4 a[108:111], v2, s[16:19], s56 offen nt
    s_waitcnt vmcnt(11)
    s_xor_b32 s101, s53, s100
    buffer_load_dwordx4 v[216:219], v1, s[8:11], s101 offen nt
    s_add_u32 s53, s53, 1024
    v_add_f32_dpp v75, v75, v75 row_ror:8 row_mask:0xf bank_mask:0xf
    v_add_f32_dpp v76, v76, v76 row_ror:8 row_mask:0xf bank_mask:0xf
    s_nop 0
    v_add_f32_dpp v75, v75, v75 row_ror:4 row_mask:0xf bank_mask:0xf
    v_add_f32_dpp v76, v76, v76 row_ror:4 row_mask:0xf bank_mask:0xf
    s_nop 0
    v_add_f32_dpp v75, v75, v75 row_ror:2 row_mask:0xf bank_mask:0xf
    v_add_f32_dpp v76, v76, v76 row_ror:2 row_mask:0xf bank_mask:0xf
    s_nop 0
    v_add_f32_dpp v75, v75, v75 row_ror:1 row_mask:0xf bank_mask:0xf
    v_add_f32_dpp v76, v76, v76 row_ror:1 row_mask:0xf bank_mask:0xf
    v_mov_b32 v80, v75
    v_mov_b32 v81, v76
    s_nop 0
    v_permlane16_swap_b32 v75, v80
    v_permlane16_swap_b32 v76, v81
    v_add_f32 v75, v75, v80
    v_add_f32 v76, v76, v81
    v_mov_b32 v80, v75
    v_mov_b32 v81, v76
    s_nop 0
    v_permlane32_swap_b32 v75, v80
    v_permlane32_swap_b32 v76, v81
    v_add_f32 v75, v75, v80
    v_add_f32 v76, v76, v81
    s_lshl_b32 s58, s3, 3
    v_mov_b32 v80, s58
    v_mov_b32 v82, v75
    v_mov_b32 v83, v76
    ds_write_b64 v80, v[82:83] offset:8256
    s_add_u32 s56, s14, s15
    s_add_u32 s15, s15, 0x8000
    s_and_b32 s15, s15, 0x3ffff
    buffer_load_dwordx4 a[112:115], v2, s[16:19], s56 offen nt
    s_waitcnt vmcnt(11)
    s_xor_b32 s101, s53, s100
    buffer_load_dwordx4 v[220:223], v1, s[8:11], s101 offen nt
    s_add_u32 s53, s53, 13312
    s_add_u32 s56, s56, 8192
    buffer_load_dwordx4 a[116:119], v2, s[16:19], s56 offen nt
    s_add_u32 s56, s56, 8192
    buffer_load_dwordx4 a[120:123], v2, s[16:19], s56 offen nt
    s_waitcnt vmcnt(12)
    s_xor_b32 s101, s53, s100
    buffer_load_dwordx4 v[224:227], v1, s[8:11], s101 offen nt
    s_add_u32 s53, s53, 1024
    s_add_u32 s56, s56, 8192
    buffer_load_dwordx4 a[124:127], v2, s[16:19], s56 offen nt
    s_waitcnt vmcnt(12)
    s_xor_b32 s101, s53, s100
    buffer_load_dwordx4 v[228:231], v1, s[8:11], s101 offen nt
    s_add_u32 s53, s53, 1024
    s_lshl_b32 s14, s50, 17
    s_lshl_b32 s59, s3, 8
    s_add_u32 s14, s14, s59
    s_mov_b32 s15, 0
    s_waitcnt lgkmcnt(0)
    s_call_b64 s[48:49], L_gemv
    s_lshl_b32 s58, s3, 9
    v_add_u32 v34, s58, v35
    ds_write_b128 v34, v[36:39] offset:4096
    s_xor_b32 s101, s53, s100
    buffer_load_dwordx4 v[232:235], v1, s[8:11], s101 offen nt
    s_add_u32 s53, s53, 1024
    s_xor_b32 s101, s53, s100
    buffer_load_dwordx4 v[236:239], v1, s[8:11], s101 offen nt
    s_add_u32 s53, s53, 13312
    s_xor_b32 s101, s53, s100
    buffer_load_dwordx4 v[240:243], v1, s[8:11], s101 offen nt
    s_add_u32 s53, s53, 1024
    s_xor_b32 s101, s53, s100
    buffer_load_dwordx4 v[244:247], v1, s[8:11], s101 offen nt
    s_add_u32 s53, s53, 1024
    s_xor_b32 s101, s53, s100
    buffer_load_dwordx4 v[248:251], v1, s[8:11], s101 offen nt
    s_add_u32 s53, s53, 1024
    s_xor_b32 s101, s53, s100
    buffer_load_dwordx4 v[252:255], v1, s[8:11], s101 offen nt
    s_add_u32 s53, s53, 13312
    v_and_b32 v32, 0xf0, v1
    v_lshlrev_b32 v32, 1, v32
    s_waitcnt lgkmcnt(0)
    s_barrier
    ds_read_b128 v[40:43], v32 offset:4096
    ds_read_b128 v[44:47], v32 offset:4112
    ds_read_b128 v[48:51], v32 offset:4608
    ds_read_b128 v[52:55], v32 offset:4624
    ds_read_b128 v[80:83], v32 offset:5120
    ds_read_b128 v[84:87], v32 offset:5136
    ds_read_b128 v[88:91], v32 offset:5632
    ds_read_b128 v[92:95], v32 offset:5648
    s_add_u32 s55, s55, 0x9e3779b1
    s_waitcnt lgkmcnt(0)
    v_add_f32 v40, v40, v48
    v_add_f32 v80, v80, v88
    v_add_f32 v41, v41, v49
    v_add_f32 v81, v81, v89
    v_add_f32 v42, v42, v50
    v_add_f32 v82, v82, v90
    v_add_f32 v43, v43, v51
    v_add_f32 v83, v83, v91
    v_add_f32 v44, v44, v52
    v_add_f32 v84, v84, v92
    v_add_f32 v45, v45, v53
    v_add_f32 v85, v85, v93
    v_add_f32 v46, v46, v54
    v_add_f32 v86, v86, v94
    v_add_f32 v47, v47, v55
    v_add_f32 v87, v87, v95
    v_add_f32 v40, v40, v80
    v_add_f32 v41, v41, v81
    v_add_f32 v42, v42, v82
    v_add_f32 v43, v43, v83
    v_add_f32 v44, v44, v84
    v_add_f32 v45, v45, v85
    v_add_f32 v46, v46, v86
    v_add_f32 v47, v47, v87
    v_cvt_pk_bf16_f32 v12, v40, v41
    v_cvt_pk_bf16_f32 v13, v42, v43
    v_cvt_pk_bf16_f32 v14, v44, v45
    v_cvt_pk_bf16_f32 v15, v46, v47
    s_lshl_b32 s58, s3, 14
    v_add_u32 v52, s58, v1
    s_waitcnt vmcnt(63)
    v_dot2_f32_bf16 v40, v96, v12, 0
    v_dot2_f32_bf16 v40, v97, v13, v40
    v_dot2_f32_bf16 v40, v98, v14, v40
    v_dot2_f32_bf16 v40, v99, v15, v40
    s_waitcnt vmcnt(63)
    v_dot2_f32_bf16 v41, v100, v12, 0
    s_nop 0
    v_add_f32_dpp v40, v40, v40 row_ror:8 row_mask:0xf bank_mask:0xf
    v_dot2_f32_bf16 v41, v101, v13, v41
    s_nop 0
    v_add_f32_dpp v40, v40, v40 row_ror:4 row_mask:0xf bank_mask:0xf
    v_dot2_f32_bf16 v41, v102, v14, v41
    s_nop 0
    v_add_f32_dpp v40, v40, v40 row_ror:2 row_mask:0xf bank_mask:0xf
    v_dot2_f32_bf16 v41, v103, v15, v41
    s_nop 0
    v_add_f32_dpp v42, v40, v40 row_ror:1 row_mask:0xf bank_mask:0x1
    s_waitcnt vmcnt(63)
    v_dot2_f32_bf16 v40, v104, v12, 0
    v_add_f32_dpp v41, v41, v41 row_ror:8 row_mask:0xf bank_mask:0xf
    v_dot2_f32_bf16 v40, v105, v13, v40
    s_nop 0
    v_add_f32_dpp v41, v41, v41 row_ror:4 row_mask:0xf bank_mask:0xf
    v_dot2_f32_bf16 v40, v106, v14, v40
    s_nop 0
    v_add_f32_dpp v41, v41, v41 row_ror:2 row_mask:0xf bank_mask:0xf
    v_dot2_f32_bf16 v40, v107, v15, v40
    s_nop 0
    v_add_f32_dpp v42, v41, v41 row_ror:1 row_mask:0xf bank_mask:0x2
    s_waitcnt vmcnt(63)
    v_dot2_f32_bf16 v41, v108, v12, 0
    v_add_f32_dpp v40, v40, v40 row_ror:8 row_mask:0xf bank_mask:0xf
    v_dot2_f32_bf16 v41, v109, v13, v41
    s_nop 0
    v_add_f32_dpp v40, v40, v40 row_ror:4 row_mask:0xf bank_mask:0xf
    v_dot2_f32_bf16 v41, v110, v14, v41
    s_nop 0
    v_add_f32_dpp v40, v40, v40 row_ror:2 row_mask:0xf bank_mask:0xf
    v_dot2_f32_bf16 v41, v111, v15, v41
    s_nop 0
    v_add_f32_dpp v42, v40, v40 row_ror:1 row_mask:0xf bank_mask:0x4
    s_waitcnt vmcnt(63)
    v_dot2_f32_bf16 v40, v112, v12, 0
    v_add_f32_dpp v41, v41, v41 row_ror:8 row_mask:0xf bank_mask:0xf
    v_dot2_f32_bf16 v40, v113, v13, v40
    s_nop 0
    v_add_f32_dpp v41, v41, v41 row_ror:4 row_mask:0xf bank_mask:0xf
    v_dot2_f32_bf16 v40, v114, v14, v40
    s_nop 0
    v_add_f32_dpp v41, v41, v41 row_ror:2 row_mask:0xf bank_mask:0xf
    v_dot2_f32_bf16 v40, v115, v15, v40
    s_nop 0
    v_add_f32_dpp v42, v41, v41 row_ror:1 row_mask:0xf bank_mask:0x8
    s_waitcnt vmcnt(63)
    v_dot2_f32_bf16 v41, v116, v12, 0
    v_add_f32_dpp v40, v40, v40 row_ror:8 row_mask:0xf bank_mask:0xf
    v_dot2_f32_bf16 v41, v117, v13, v41
    v_cvt_pk_bf16_f32 v42, v42, v42
    v_add_f32_dpp v40, v40, v40 row_ror:4 row_mask:0xf bank_mask:0xf
    v_dot2_f32_bf16 v41, v118, v14, v41
    v_lshlrev_b32 v42, 16, v42
    v_add_f32_dpp v40, v40, v40 row_ror:2 row_mask:0xf bank_mask:0xf
    v_dot2_f32_bf16 v41, v119, v15, v41
    s_nop 0
    v_add_f32_dpp v43, v40, v40 row_ror:1 row_mask:0xf bank_mask:0x1
    s_waitcnt vmcnt(63)
    v_dot2_f32_bf16 v40, v120, v12, 0
    v_add_f32_dpp v41, v41, v41 row_ror:8 row_mask:0xf bank_mask:0xf
    v_dot2_f32_bf16 v40, v121, v13, v40
    v_mul_f32 v42, 0x3db504f3, v42
    v_add_f32_dpp v41, v41, v41 row_ror:4 row_mask:0xf bank_mask:0xf
    v_dot2_f32_bf16 v40, v122, v14, v40
    v_cvt_pk_bf16_f32 v42, v42, v42
    v_add_f32_dpp v41, v41, v41 row_ror:2 row_mask:0xf bank_mask:0xf
    v_dot2_f32_bf16 v40, v123, v15, v40
    s_nop 0
    v_add_f32_dpp v43, v41, v41 row_ror:1 row_mask:0xf bank_mask:0x2
    s_waitcnt vmcnt(61)
    v_dot2_f32_bf16 v41, v124, v12, 0
    v_add_f32_dpp v40, v40, v40 row_ror:8 row_mask:0xf bank_mask:0xf
    v_dot2_f32_bf16 v41, v125, v13, v41
    v_lshlrev_b32 v42, 16, v42
    v_add_f32_dpp v40, v40, v40 row_ror:4 row_mask:0xf bank_mask:0xf
    v_dot2_f32_bf16 v41, v126, v14, v41
    v_max_f32 v28, v28, v42
    v_add_f32_dpp v40, v40, v40 row_ror:2 row_mask:0xf bank_mask:0xf
    v_dot2_f32_bf16 v41, v127, v15, v41
    s_nop 0
    v_add_f32_dpp v43, v40, v40 row_ror:1 row_mask:0xf bank_mask:0x4
    s_waitcnt vmcnt(59)
    v_dot2_f32_bf16 v40, v128, v12, 0
    v_add_f32_dpp v41, v41, v41 row_ror:8 row_mask:0xf bank_mask:0xf
    v_dot2_f32_bf16 v40, v129, v13, v40
    ds_write_b32 v52, v42 offset:12288
    v_add_f32_dpp v41, v41, v41 row_ror:4 row_mask:0xf bank_mask:0xf
    v_dot2_f32_bf16 v40, v130, v14, v40
    s_nop 0
    v_add_f32_dpp v41, v41, v41 row_ror:2 row_mask:0xf bank_mask:0xf
    v_dot2_f32_bf16 v40, v131, v15, v40
    s_nop 0
    v_add_f32_dpp v43, v41, v41 row_ror:1 row_mask:0xf bank_mask:0x8
    s_waitcnt vmcnt(57)
    s_xor_b32 s101, s53, s100
    buffer_load_dwordx4 v[128:131], v1, s[8:11], s101 offen nt
    v_dot2_f32_bf16 v41, v132, v12, 0
    v_add_f32_dpp v40, v40, v40 row_ror:8 row_mask:0xf bank_mask:0xf
    v_dot2_f32_bf16 v41, v133, v13, v41
    s_add_u32 s53, s53, 1024
    v_add_f32_dpp v40, v40, v40 row_ror:4 row_mask:0xf bank_mask:0xf
    v_dot2_f32_bf16 v41, v134, v14, v41
    v_cvt_pk_bf16_f32 v43, v43, v43
    v_add_f32_dpp v40, v40, v40 row_ror:2 row_mask:0xf bank_mask:0xf
    v_dot2_f32_bf16 v41, v135, v15, v41
    v_lshlrev_b32 v43, 16, v43
    v_add_f32_dpp v42, v40, v40 row_ror:1 row_mask:0xf bank_mask:0x1
    s_waitcnt vmcnt(56)
    s_xor_b32 s101, s53, s100
    buffer_load_dwordx4 v[132:135], v1, s[8:11], s101 offen nt
    v_dot2_f32_bf16 v40, v136, v12, 0
    v_add_f32_dpp v41, v41, v41 row_ror:8 row_mask:0xf bank_mask:0xf
    v_dot2_f32_bf16 v40, v137, v13, v40
    s_add_u32 s53, s53, 1024
    v_add_f32_dpp v41, v41, v41 row_ror:4 row_mask:0xf bank_mask:0xf
    v_dot2_f32_bf16 v40, v138, v14, v40
    v_mul_f32 v43, 0x3db504f3, v43
    v_add_f32_dpp v41, v41, v41 row_ror:2 row_mask:0xf bank_mask:0xf
    v_dot2_f32_bf16 v40, v139, v15, v40
    v_cvt_pk_bf16_f32 v43, v43, v43
    v_add_f32_dpp v42, v41, v41 row_ror:1 row_mask:0xf bank_mask:0x2
    s_waitcnt vmcnt(55)
    s_xor_b32 s101, s53, s100
    buffer_load_dwordx4 v[136:139], v1, s[8:11], s101 offen nt
    v_dot2_f32_bf16 v41, v140, v12, 0
    v_add_f32_dpp v40, v40, v40 row_ror:8 row_mask:0xf bank_mask:0xf
    v_dot2_f32_bf16 v41, v141, v13, v41
    s_add_u32 s53, s53, 1024
    v_add_f32_dpp v40, v40, v40 row_ror:4 row_mask:0xf bank_mask:0xf
    v_dot2_f32_bf16 v41, v142, v14, v41
    v_lshlrev_b32 v43, 16, v43
    v_add_f32_dpp v40, v40, v40 row_ror:2 row_mask:0xf bank_mask:0xf
    v_dot2_f32_bf16 v41, v143, v15, v41
    v_max_f32 v28, v28, v43
    v_add_f32_dpp v42, v40, v40 row_ror:1 row_mask:0xf bank_mask:0x4
    s_waitcnt vmcnt(54)
    v_dot2_f32_bf16 v40, v144, v12, 0
    v_add_f32_dpp v41, v41, v41 row_ror:8 row_mask:0xf bank_mask:0xf
    v_dot2_f32_bf16 v40, v145, v13, v40
    ds_write_b32 v52, v43 offset:12292
    v_add_f32_dpp v41, v41, v41 row_ror:4 row_mask:0xf bank_mask:0xf
    v_dot2_f32_bf16 v40, v146, v14, v40
    s_nop 0
    v_add_f32_dpp v41, v41, v41 row_ror:2 row_mask:0xf bank_mask:0xf
    v_dot2_f32_bf16 v40, v147, v15, v40
    s_nop 0
    v_add_f32_dpp v42, v41, v41 row_ror:1 row_mask:0xf bank_mask:0x8
    s_waitcnt vmcnt(52)
    v_dot2_f32_bf16 v41, v148, v12, 0
    v_add_f32_dpp v40, v40, v40 row_ror:8 row_mask:0xf bank_mask:0xf
    v_dot2_f32_bf16 v41, v149, v13, v41
    v_cvt_pk_bf16_f32 v42, v42, v42
    v_add_f32_dpp v40, v40, v40 row_ror:4 row_mask:0xf bank_mask:0xf
    v_dot2_f32_bf16 v41, v150, v14, v41
    v_lshlrev_b32 v42, 16, v42
    v_add_f32_dpp v40, v40, v40 row_ror:2 row_mask:0xf bank_mask:0xf
    v_dot2_f32_bf16 v41, v151, v15, v41
    s_nop 0
    v_add_f32_dpp v43, v40, v40 row_ror:1 row_mask:0xf bank_mask:0x1
    s_waitcnt vmcnt(49)
    v_dot2_f32_bf16 v40, v152, v12, 0
    v_add_f32_dpp v41, v41, v41 row_ror:8 row_mask:0xf bank_mask:0xf
    v_dot2_f32_bf16 v40, v153, v13, v40
    v_mul_f32 v42, 0x3db504f3, v42
    v_add_f32_dpp v41, v41, v41 row_ror:4 row_mask:0xf bank_mask:0xf
    v_dot2_f32_bf16 v40, v154, v14, v40
    v_cvt_pk_bf16_f32 v42, v42, v42
    v_add_f32_dpp v41, v41, v41 row_ror:2 row_mask:0xf bank_mask:0xf
    v_dot2_f32_bf16 v40, v155, v15, v40
    s_nop 0
    v_add_f32_dpp v43, v41, v41 row_ror:1 row_mask:0xf bank_mask:0x2
    s_waitcnt vmcnt(47)
    s_xor_b32 s101, s53, s100
    buffer_load_dwordx4 v[140:143], v1, s[8:11], s101 offen nt
    v_dot2_f32_bf16 v41, v156, v12, 0
    v_add_f32_dpp v40, v40, v40 row_ror:8 row_mask:0xf bank_mask:0xf
    v_dot2_f32_bf16 v41, v157, v13, v41
    s_add_u32 s53, s53, 13312
    v_add_f32_dpp v40, v40, v40 row_ror:4 row_mask:0xf bank_mask:0xf
    v_dot2_f32_bf16 v41, v158, v14, v41
    v_lshlrev_b32 v42, 16, v42
    v_add_f32_dpp v40, v40, v40 row_ror:2 row_mask:0xf bank_mask:0xf
    v_dot2_f32_bf16 v41, v159, v15, v41
    v_max_f32 v28, v28, v42
    v_add_f32_dpp v43, v40, v40 row_ror:1 row_mask:0xf bank_mask:0x4
    s_waitcnt vmcnt(46)
    v_dot2_f32_bf16 v40, v160, v12, 0
    v_add_f32_dpp v41, v41, v41 row_ror:8 row_mask:0xf bank_mask:0xf
    v_dot2_f32_bf16 v40, v161, v13, v40
    ds_write_b32 v52, v42 offset:12296
    v_add_f32_dpp v41, v41, v41 row_ror:4 row_mask:0xf bank_mask:0xf
    v_dot2_f32_bf16 v40, v162, v14, v40
    s_nop 0
    v_add_f32_dpp v41, v41, v41 row_ror:2 row_mask:0xf bank_mask:0xf
    v_dot2_f32_bf16 v40, v163, v15, v40
    s_nop 0
    v_add_f32_dpp v43, v41, v41 row_ror:1 row_mask:0xf bank_mask:0x8
    s_waitcnt vmcnt(44)
    v_dot2_f32_bf16 v41, v164, v12, 0
    v_add_f32_dpp v40, v40, v40 row_ror:8 row_mask:0xf bank_mask:0xf
    v_dot2_f32_bf16 v41, v165, v13, v41
    v_cvt_pk_bf16_f32 v43, v43, v43
    v_add_f32_dpp v40, v40, v40 row_ror:4 row_mask:0xf bank_mask:0xf
    v_dot2_f32_bf16 v41, v166, v14, v41
    v_lshlrev_b32 v43, 16, v43
    v_add_f32_dpp v40, v40, v40 row_ror:2 row_mask:0xf bank_mask:0xf
    v_dot2_f32_bf16 v41, v167, v15, v41
    s_nop 0
    v_add_f32_dpp v42, v40, v40 row_ror:1 row_mask:0xf bank_mask:0x1
    s_waitcnt vmcnt(42)
    v_dot2_f32_bf16 v40, v168, v12, 0
    v_add_f32_dpp v41, v41, v41 row_ror:8 row_mask:0xf bank_mask:0xf
    v_dot2_f32_bf16 v40, v169, v13, v40
    v_mul_f32 v43, 0x3db504f3, v43
    v_add_f32_dpp v41, v41, v41 row_ror:4 row_mask:0xf bank_mask:0xf
    v_dot2_f32_bf16 v40, v170, v14, v40
    v_cvt_pk_bf16_f32 v43, v43, v43
    v_add_f32_dpp v41, v41, v41 row_ror:2 row_mask:0xf bank_mask:0xf
    v_dot2_f32_bf16 v40, v171, v15, v40
    s_nop 0
    v_add_f32_dpp v42, v41, v41 row_ror:1 row_mask:0xf bank_mask:0x2
    s_waitcnt vmcnt(40)
    s_xor_b32 s101, s53, s100
    buffer_load_dwordx4 v[144:147], v1, s[8:11], s101 offen nt
    v_dot2_f32_bf16 v41, v172, v12, 0
    v_add_f32_dpp v40, v40, v40 row_ror:8 row_mask:0xf bank_mask:0xf
    v_dot2_f32_bf16 v41, v173, v13, v41
    s_add_u32 s53, s53, 1024
    v_add_f32_dpp v40, v40, v40 row_ror:4 row_mask:0xf bank_mask:0xf
    v_dot2_f32_bf16 v41, v174, v14, v41
    v_lshlrev_b32 v43, 16, v43
    v_add_f32_dpp v40, v40, v40 row_ror:2 row_mask:0xf bank_mask:0xf
    v_dot2_f32_bf16 v41, v175, v15, v41
    v_max_f32 v28, v28, v43
    v_add_f32_dpp v42, v40, v40 row_ror:1 row_mask:0xf bank_mask:0x4
    s_waitcnt vmcnt(39)
    v_dot2_f32_bf16 v40, v176, v12, 0
    v_add_f32_dpp v41, v41, v41 row_ror:8 row_mask:0xf bank_mask:0xf
    v_dot2_f32_bf16 v40, v177, v13, v40
    ds_write_b32 v52, v43 offset:12300
    v_add_f32_dpp v41, v41, v41 row_ror:4 row_mask:0xf bank_mask:0xf
    v_dot2_f32_bf16 v40, v178, v14, v40
    v_add_u32 v52, 0x400, v52
    v_add_f32_dpp v41, v41, v41 row_ror:2 row_mask:0xf bank_mask:0xf
    v_dot2_f32_bf16 v40, v179, v15, v40
    s_nop 0
    v_add_f32_dpp v42, v41, v41 row_ror:1 row_mask:0xf bank_mask:0x8
    s_waitcnt vmcnt(37)
    v_dot2_f32_bf16 v41, v180, v12, 0
    v_add_f32_dpp v40, v40, v40 row_ror:8 row_mask:0xf bank_mask:0xf
    v_dot2_f32_bf16 v41, v181, v13, v41
    v_cvt_pk_bf16_f32 v42, v42, v42
    v_add_f32_dpp v40, v40, v40 row_ror:4 row_mask:0xf bank_mask:0xf
    v_dot2_f32_bf16 v41, v182, v14, v41
    v_lshlrev_b32 v42, 16, v42
    v_add_f32_dpp v40, v40, v40 row_ror:2 row_mask:0xf bank_mask:0xf
    v_dot2_f32_bf16 v41, v183, v15, v41
    s_nop 0
    v_add_f32_dpp v43, v40, v40 row_ror:1 row_mask:0xf bank_mask:0x1
    s_waitcnt vmcnt(35)
    v_dot2_f32_bf16 v40, v184, v12, 0
    v_add_f32_dpp v41, v41, v41 row_ror:8 row_mask:0xf bank_mask:0xf
    v_dot2_f32_bf16 v40, v185, v13, v40
    v_mul_f32 v42, 0x3db504f3, v42
    v_add_f32_dpp v41, v41, v41 row_ror:4 row_mask:0xf bank_mask:0xf
    v_dot2_f32_bf16 v40, v186, v14, v40
    v_cvt_pk_bf16_f32 v42, v42, v42
    v_add_f32_dpp v41, v41, v41 row_ror:2 row_mask:0xf bank_mask:0xf
    v_dot2_f32_bf16 v40, v187, v15, v40
    s_nop 0
    v_add_f32_dpp v43, v41, v41 row_ror:1 row_mask:0xf bank_mask:0x2
    s_waitcnt vmcnt(32)
    s_xor_b32 s101, s53, s100
    buffer_load_dwordx4 v[148:151], v1, s[8:11], s101 offen nt
    v_dot2_f32_bf16 v41, v188, v12, 0
    v_add_f32_dpp v40, v40, v40 row_ror:8 row_mask:0xf bank_mask:0xf
    v_dot2_f32_bf16 v41, v189, v13, v41
    s_add_u32 s53, s53, 1024
    v_add_f32_dpp v40, v40, v40 row_ror:4 row_mask:0xf bank_mask:0xf
    v_dot2_f32_bf16 v41, v190, v14, v41
    v_lshlrev_b32 v42, 16, v42
    v_add_f32_dpp v40, v40, v40 row_ror:2 row_mask:0xf bank_mask:0xf
    v_dot2_f32_bf16 v41, v191, v15, v41
    v_max_f32 v28, v28, v42
    v_add_f32_dpp v43, v40, v40 row_ror:1 row_mask:0xf bank_mask:0x4
    s_waitcnt vmcnt(31)
    v_dot2_f32_bf16 v40, v192, v12, 0
    v_add_f32_dpp v41, v41, v41 row_ror:8 row_mask:0xf bank_mask:0xf
    v_dot2_f32_bf16 v40, v193, v13, v40
    ds_write_b32 v52, v42 offset:12288
    v_add_f32_dpp v41, v41, v41 row_ror:4 row_mask:0xf bank_mask:0xf
    v_dot2_f32_bf16 v40, v194, v14, v40
    s_nop 0
    v_add_f32_dpp v41, v41, v41 row_ror:2 row_mask:0xf bank_mask:0xf
    v_dot2_f32_bf16 v40, v195, v15, v40
    s_nop 0
    v_add_f32_dpp v43, v41, v41 row_ror:1 row_mask:0xf bank_mask:0x8
    s_waitcnt vmcnt(29)
    v_dot2_f32_bf16 v41, v196, v12, 0
    v_add_f32_dpp v40, v40, v40 row_ror:8 row_mask:0xf bank_mask:0xf
    v_dot2_f32_bf16 v41, v197, v13, v41
    v_cvt_pk_bf16_f32 v43, v43, v43
    v_add_f32_dpp v40, v40, v40 row_ror:4 row_mask:0xf bank_mask:0xf
    v_dot2_f32_bf16 v41, v198, v14, v41
    v_lshlrev_b32 v43, 16, v43
    v_add_f32_dpp v40, v40, v40 row_ror:2 row_mask:0xf bank_mask:0xf
    v_dot2_f32_bf16 v41, v199, v15, v41
    s_nop 0
    v_add_f32_dpp v42, v40, v40 row_ror:1 row_mask:0xf bank_mask:0x1
    s_waitcnt vmcnt(27)
    v_dot2_f32_bf16 v40, v200, v12, 0
    v_add_f32_dpp v41, v41, v41 row_ror:8 row_mask:0xf bank_mask:0xf
    v_dot2_f32_bf16 v40, v201, v13, v40
    v_mul_f32 v43, 0x3db504f3, v43
    v_add_f32_dpp v41, v41, v41 row_ror:4 row_mask:0xf bank_mask:0xf
    v_dot2_f32_bf16 v40, v202, v14, v40
    v_cvt_pk_bf16_f32 v43, v43, v43
    v_add_f32_dpp v41, v41, v41 row_ror:2 row_mask:0xf bank_mask:0xf
    v_dot2_f32_bf16 v40, v203, v15, v40
    s_nop 0
    v_add_f32_dpp v42, v41, v41 row_ror:1 row_mask:0xf bank_mask:0x2
    s_waitcnt vmcnt(25)
    s_xor_b32 s101, s53, s100
    buffer_load_dwordx4 v[152:155], v1, s[8:11], s101 offen nt
    v_dot2_f32_bf16 v41, v204, v12, 0
    v_add_f32_dpp v40, v40, v40 row_ror:8 row_mask:0xf bank_mask:0xf
    v_dot2_f32_bf16 v41, v205, v13, v41
    s_add_u32 s53, s53, 1024
    v_add_f32_dpp v40, v40, v40 row_ror:4 row_mask:0xf bank_mask:0xf
    v_dot2_f32_bf16 v41, v206, v14, v41
    v_lshlrev_b32 v43, 16, v43
    v_add_f32_dpp v40, v40, v40 row_ror:2 row_mask:0xf bank_mask:0xf
    v_dot2_f32_bf16 v41, v207, v15, v41
    v_max_f32 v28, v28, v43
    v_add_f32_dpp v42, v40, v40 row_ror:1 row_mask:0xf bank_mask:0x4
    s_waitcnt vmcnt(24)
    v_dot2_f32_bf16 v40, v208, v12, 0
    v_add_f32_dpp v41, v41, v41 row_ror:8 row_mask:0xf bank_mask:0xf
    v_dot2_f32_bf16 v40, v209, v13, v40
    ds_write_b32 v52, v43 offset:12292
    v_add_f32_dpp v41, v41, v41 row_ror:4 row_mask:0xf bank_mask:0xf
    v_dot2_f32_bf16 v40, v210, v14, v40
    s_nop 0
    v_add_f32_dpp v41, v41, v41 row_ror:2 row_mask:0xf bank_mask:0xf
    v_dot2_f32_bf16 v40, v211, v15, v40
    s_nop 0
    v_add_f32_dpp v42, v41, v41 row_ror:1 row_mask:0xf bank_mask:0x8
    s_waitcnt vmcnt(22)
    v_dot2_f32_bf16 v41, v212, v12, 0
    v_add_f32_dpp v40, v40, v40 row_ror:8 row_mask:0xf bank_mask:0xf
    v_dot2_f32_bf16 v41, v213, v13, v41
    v_cvt_pk_bf16_f32 v42, v42, v42
    v_add_f32_dpp v40, v40, v40 row_ror:4 row_mask:0xf bank_mask:0xf
    v_dot2_f32_bf16 v41, v214, v14, v41
    v_lshlrev_b32 v42, 16, v42
    v_add_f32_dpp v40, v40, v40 row_ror:2 row_mask:0xf bank_mask:0xf
    v_dot2_f32_bf16 v41, v215, v15, v41
    s_nop 0
    v_add_f32_dpp v43, v40, v40 row_ror:1 row_mask:0xf bank_mask:0x1
    s_waitcnt vmcnt(20)
    v_dot2_f32_bf16 v40, v216, v12, 0
    v_add_f32_dpp v41, v41, v41 row_ror:8 row_mask:0xf bank_mask:0xf
    v_dot2_f32_bf16 v40, v217, v13, v40
    v_mul_f32 v42, 0x3db504f3, v42
    v_add_f32_dpp v41, v41, v41 row_ror:4 row_mask:0xf bank_mask:0xf
    v_dot2_f32_bf16 v40, v218, v14, v40
    v_cvt_pk_bf16_f32 v42, v42, v42
    v_add_f32_dpp v41, v41, v41 row_ror:2 row_mask:0xf bank_mask:0xf
    v_dot2_f32_bf16 v40, v219, v15, v40
    s_nop 0
    v_add_f32_dpp v43, v41, v41 row_ror:1 row_mask:0xf bank_mask:0x2
    s_waitcnt vmcnt(18)
    s_xor_b32 s101, s53, s100
    buffer_load_dwordx4 v[156:159], v1, s[8:11], s101 offen nt
    v_dot2_f32_bf16 v41, v220, v12, 0
    v_add_f32_dpp v40, v40, v40 row_ror:8 row_mask:0xf bank_mask:0xf
    v_dot2_f32_bf16 v41, v221, v13, v41
    s_add_u32 s53, s53, 13312
    v_add_f32_dpp v40, v40, v40 row_ror:4 row_mask:0xf bank_mask:0xf
    v_dot2_f32_bf16 v41, v222, v14, v41
    v_lshlrev_b32 v42, 16, v42
    v_add_f32_dpp v40, v40, v40 row_ror:2 row_mask:0xf bank_mask:0xf
    v_dot2_f32_bf16 v41, v223, v15, v41
    v_max_f32 v28, v28, v42
    v_add_f32_dpp v43, v40, v40 row_ror:1 row_mask:0xf bank_mask:0x4
    s_waitcnt vmcnt(16)
    v_dot2_f32_bf16 v40, v224, v12, 0
    v_add_f32_dpp v41, v41, v41 row_ror:8 row_mask:0xf bank_mask:0xf
    v_dot2_f32_bf16 v40, v225, v13, v40
    ds_write_b32 v52, v42 offset:12296
    v_add_f32_dpp v41, v41, v41 row_ror:4 row_mask:0xf bank_mask:0xf
    v_dot2_f32_bf16 v40, v226, v14, v40
    s_nop 0
    v_add_f32_dpp v41, v41, v41 row_ror:2 row_mask:0xf bank_mask:0xf
    v_dot2_f32_bf16 v40, v227, v15, v40
    s_nop 0
    v_add_f32_dpp v43, v41, v41 row_ror:1 row_mask:0xf bank_mask:0x8
    s_add_u32 s56, s14, s15
    s_add_u32 s15, s15, 4096
    s_and_b32 s15, s15, 0x7fff
    buffer_load_dwordx4 a[0:3], v3, s[20:23], s56 offen offset:0 nt
    s_waitcnt vmcnt(15)
    v_dot2_f32_bf16 v41, v228, v12, 0
    v_add_f32_dpp v40, v40, v40 row_ror:8 row_mask:0xf bank_mask:0xf
    v_dot2_f32_bf16 v41, v229, v13, v41
    v_cvt_pk_bf16_f32 v43, v43, v43
    v_add_f32_dpp v40, v40, v40 row_ror:4 row_mask:0xf bank_mask:0xf
    v_dot2_f32_bf16 v41, v230, v14, v41
    v_lshlrev_b32 v43, 16, v43
    v_add_f32_dpp v40, v40, v40 row_ror:2 row_mask:0xf bank_mask:0xf
    v_dot2_f32_bf16 v41, v231, v15, v41
    s_nop 0
    v_add_f32_dpp v42, v40, v40 row_ror:1 row_mask:0xf bank_mask:0x1
    s_waitcnt vmcnt(14)
    v_dot2_f32_bf16 v40, v232, v12, 0
    v_add_f32_dpp v41, v41, v41 row_ror:8 row_mask:0xf bank_mask:0xf
    v_dot2_f32_bf16 v40, v233, v13, v40
    v_mul_f32 v43, 0x3db504f3, v43
    v_add_f32_dpp v41, v41, v41 row_ror:4 row_mask:0xf bank_mask:0xf
    v_dot2_f32_bf16 v40, v234, v14, v40
    v_cvt_pk_bf16_f32 v43, v43, v43
    v_add_f32_dpp v41, v41, v41 row_ror:2 row_mask:0xf bank_mask:0xf
    v_dot2_f32_bf16 v40, v235, v15, v40
    s_nop 0
    v_add_f32_dpp v42, v41, v41 row_ror:1 row_mask:0xf bank_mask:0x2
    buffer_load_dwordx4 a[4:7], v3, s[20:23], s56 offen offset:1024 nt
    s_waitcnt vmcnt(14)
    s_xor_b32 s101, s53, s100
    buffer_load_dwordx4 v[96:99], v1, s[8:11], s101 offen nt
    v_dot2_f32_bf16 v41, v236, v12, 0
    v_add_f32_dpp v40, v40, v40 row_ror:8 row_mask:0xf bank_mask:0xf
    v_dot2_f32_bf16 v41, v237, v13, v41
    s_add_u32 s53, s53, 1024
    v_add_f32_dpp v40, v40, v40 row_ror:4 row_mask:0xf bank_mask:0xf
    v_dot2_f32_bf16 v41, v238, v14, v41
    v_lshlrev_b32 v43, 16, v43
    v_add_f32_dpp v40, v40, v40 row_ror:2 row_mask:0xf bank_mask:0xf
    v_dot2_f32_bf16 v41, v239, v15, v41
    v_max_f32 v28, v28, v43
    v_add_f32_dpp v42, v40, v40 row_ror:1 row_mask:0xf bank_mask:0x4
    s_waitcnt vmcnt(14)
    v_dot2_f32_bf16 v40, v240, v12, 0
    v_add_f32_dpp v41, v41, v41 row_ror:8 row_mask:0xf bank_mask:0xf
    v_dot2_f32_bf16 v40, v241, v13, v40
    ds_write_b32 v52, v43 offset:12300
    v_add_f32_dpp v41, v41, v41 row_ror:4 row_mask:0xf bank_mask:0xf
    v_dot2_f32_bf16 v40, v242, v14, v40
    v_add_u32 v52, 0x400, v52
    v_add_f32_dpp v41, v41, v41 row_ror:2 row_mask:0xf bank_mask:0xf
    v_dot2_f32_bf16 v40, v243, v15, v40
    s_nop 0
    v_add_f32_dpp v42, v41, v41 row_ror:1 row_mask:0xf bank_mask:0x8
    buffer_load_dwordx4 a[8:11], v3, s[20:23], s56 offen offset:2048 nt
    s_waitcnt vmcnt(14)
    v_dot2_f32_bf16 v41, v244, v12, 0
    v_add_f32_dpp v40, v40, v40 row_ror:8 row_mask:0xf bank_mask:0xf
    v_dot2_f32_bf16 v41, v245, v13, v41
    v_cvt_pk_bf16_f32 v42, v42, v42
    v_add_f32_dpp v40, v40, v40 row_ror:4 row_mask:0xf bank_mask:0xf
    v_dot2_f32_bf16 v41, v246, v14, v41
    v_lshlrev_b32 v42, 16, v42
    v_add_f32_dpp v40, v40, v40 row_ror:2 row_mask:0xf bank_mask:0xf
    v_dot2_f32_bf16 v41, v247, v15, v41
    s_nop 0
    v_add_f32_dpp v43, v40, v40 row_ror:1 row_mask:0xf bank_mask:0x1
    s_waitcnt vmcnt(13)
    v_dot2_f32_bf16 v40, v248, v12, 0
    v_add_f32_dpp v41, v41, v41 row_ror:8 row_mask:0xf bank_mask:0xf
    v_dot2_f32_bf16 v40, v249, v13, v40
    v_mul_f32 v42, 0x3db504f3, v42
    v_add_f32_dpp v41, v41, v41 row_ror:4 row_mask:0xf bank_mask:0xf
    v_dot2_f32_bf16 v40, v250, v14, v40
    v_cvt_pk_bf16_f32 v42, v42, v42
    v_add_f32_dpp v41, v41, v41 row_ror:2 row_mask:0xf bank_mask:0xf
    v_dot2_f32_bf16 v40, v251, v15, v40
    s_nop 0
    v_add_f32_dpp v43, v41, v41 row_ror:1 row_mask:0xf bank_mask:0x2
    buffer_load_dwordx4 a[12:15], v3, s[20:23], s56 offen offset:3072 nt
    s_waitcnt vmcnt(13)
    s_xor_b32 s101, s53, s100
    buffer_load_dwordx4 v[100:103], v1, s[8:11], s101 offen nt
    v_dot2_f32_bf16 v41, v252, v12, 0
    v_add_f32_dpp v40, v40, v40 row_ror:8 row_mask:0xf bank_mask:0xf
    v_dot2_f32_bf16 v41, v253, v13, v41
    s_add_u32 s53, s53, 1024
    v_add_f32_dpp v40, v40, v40 row_ror:4 row_mask:0xf bank_mask:0xf
    v_dot2_f32_bf16 v41, v254, v14, v41
    v_lshlrev_b32 v42, 16, v42
    v_add_f32_dpp v40, v40, v40 row_ror:2 row_mask:0xf bank_mask:0xf
    v_dot2_f32_bf16 v41, v255, v15, v41
    v_max_f32 v28, v28, v42
    v_add_f32_dpp v43, v40, v40 row_ror:1 row_mask:0xf bank_mask:0x4
    s_waitcnt vmcnt(13)
    v_dot2_f32_bf16 v40, v128, v12, 0
    v_add_f32_dpp v41, v41, v41 row_ror:8 row_mask:0xf bank_mask:0xf
    v_dot2_f32_bf16 v40, v129, v13, v40
    ds_write_b32 v52, v42 offset:12288
    v_add_f32_dpp v41, v41, v41 row_ror:4 row_mask:0xf bank_mask:0xf
    v_dot2_f32_bf16 v40, v130, v14, v40
    s_nop 0
    v_add_f32_dpp v41, v41, v41 row_ror:2 row_mask:0xf bank_mask:0xf
    v_dot2_f32_bf16 v40, v131, v15, v40
    s_nop 0
    v_add_f32_dpp v43, v41, v41 row_ror:1 row_mask:0xf bank_mask:0x8
    s_add_u32 s56, s14, s15
    s_add_u32 s15, s15, 4096
    s_and_b32 s15, s15, 0x7fff
    buffer_load_dwordx4 a[16:19], v3, s[20:23], s56 offen offset:0 nt
    s_waitcnt vmcnt(13)
    v_dot2_f32_bf16 v41, v132, v12, 0
    v_add_f32_dpp v40, v40, v40 row_ror:8 row_mask:0xf bank_mask:0xf
    v_dot2_f32_bf16 v41, v133, v13, v41
    v_cvt_pk_bf16_f32 v43, v43, v43
    v_add_f32_dpp v40, v40, v40 row_ror:4 row_mask:0xf bank_mask:0xf
    v_dot2_f32_bf16 v41, v134, v14, v41
    v_lshlrev_b32 v43, 16, v43
    v_add_f32_dpp v40, v40, v40 row_ror:2 row_mask:0xf bank_mask:0xf
    v_dot2_f32_bf16 v41, v135, v15, v41
    s_nop 0
    v_add_f32_dpp v42, v40, v40 row_ror:1 row_mask:0xf bank_mask:0x1
    s_waitcnt vmcnt(12)
    v_dot2_f32_bf16 v40, v136, v12, 0
    v_add_f32_dpp v41, v41, v41 row_ror:8 row_mask:0xf bank_mask:0xf
    v_dot2_f32_bf16 v40, v137, v13, v40
    v_mul_f32 v43, 0x3db504f3, v43
    v_add_f32_dpp v41, v41, v41 row_ror:4 row_mask:0xf bank_mask:0xf
    v_dot2_f32_bf16 v40, v138, v14, v40
    v_cvt_pk_bf16_f32 v43, v43, v43
    v_add_f32_dpp v41, v41, v41 row_ror:2 row_mask:0xf bank_mask:0xf
    v_dot2_f32_bf16 v40, v139, v15, v40
    s_nop 0
    v_add_f32_dpp v42, v41, v41 row_ror:1 row_mask:0xf bank_mask:0x2
    buffer_load_dwordx4 a[20:23], v3, s[20:23], s56 offen offset:1024 nt
    s_waitcnt vmcnt(12)
    s_xor_b32 s101, s53, s100
    buffer_load_dwordx4 v[104:107], v1, s[8:11], s101 offen nt
    v_dot2_f32_bf16 v41, v140, v12, 0
    v_add_f32_dpp v40, v40, v40 row_ror:8 row_mask:0xf bank_mask:0xf
    v_dot2_f32_bf16 v41, v141, v13, v41
    s_add_u32 s53, s53, 1024
    v_add_f32_dpp v40, v40, v40 row_ror:4 row_mask:0xf bank_mask:0xf
    v_dot2_f32_bf16 v41, v142, v14, v41
    v_lshlrev_b32 v43, 16, v43
    v_add_f32_dpp v40, v40, v40 row_ror:2 row_mask:0xf bank_mask:0xf
    v_dot2_f32_bf16 v41, v143, v15, v41
    v_max_f32 v28, v28, v43
    v_add_f32_dpp v42, v40, v40 row_ror:1 row_mask:0xf bank_mask:0x4
    s_waitcnt vmcnt(12)
    v_dot2_f32_bf16 v40, v144, v12, 0
    v_add_f32_dpp v41, v41, v41 row_ror:8 row_mask:0xf bank_mask:0xf
    v_dot2_f32_bf16 v40, v145, v13, v40
    ds_write_b32 v52, v43 offset:12292
    v_add_f32_dpp v41, v41, v41 row_ror:4 row_mask:0xf bank_mask:0xf
    v_dot2_f32_bf16 v40, v146, v14, v40
    s_nop 0
    v_add_f32_dpp v41, v41, v41 row_ror:2 row_mask:0xf bank_mask:0xf
    v_dot2_f32_bf16 v40, v147, v15, v40
    s_nop 0
    v_add_f32_dpp v42, v41, v41 row_ror:1 row_mask:0xf bank_mask:0x8
    buffer_load_dwordx4 a[24:27], v3, s[20:23], s56 offen offset:2048 nt
    s_waitcnt vmcnt(12)
    v_dot2_f32_bf16 v41, v148, v12, 0
    v_add_f32_dpp v40, v40, v40 row_ror:8 row_mask:0xf bank_mask:0xf
    v_dot2_f32_bf16 v41, v149, v13, v41
    v_cvt_pk_bf16_f32 v42, v42, v42
    v_add_f32_dpp v40, v40, v40 row_ror:4 row_mask:0xf bank_mask:0xf
    v_dot2_f32_bf16 v41, v150, v14, v41
    v_lshlrev_b32 v42, 16, v42
    v_add_f32_dpp v40, v40, v40 row_ror:2 row_mask:0xf bank_mask:0xf
    v_dot2_f32_bf16 v41, v151, v15, v41
    s_nop 0
    v_add_f32_dpp v43, v40, v40 row_ror:1 row_mask:0xf bank_mask:0x1
    s_waitcnt vmcnt(11)
    s_xor_b32 s101, s53, s100
    buffer_load_dwordx4 v[108:111], v1, s[8:11], s101 offen nt
    v_dot2_f32_bf16 v40, v152, v12, 0
    v_add_f32_dpp v41, v41, v41 row_ror:8 row_mask:0xf bank_mask:0xf
    v_dot2_f32_bf16 v40, v153, v13, v40
    s_add_u32 s53, s53, 13312
    v_add_f32_dpp v41, v41, v41 row_ror:4 row_mask:0xf bank_mask:0xf
    v_dot2_f32_bf16 v40, v154, v14, v40
    v_mul_f32 v42, 0x3db504f3, v42
    v_add_f32_dpp v41, v41, v41 row_ror:2 row_mask:0xf bank_mask:0xf
    v_dot2_f32_bf16 v40, v155, v15, v40
    v_cvt_pk_bf16_f32 v42, v42, v42
    v_add_f32_dpp v43, v41, v41 row_ror:1 row_mask:0xf bank_mask:0x2
    buffer_load_dwordx4 a[28:31], v3, s[20:23], s56 offen offset:3072 nt
    s_waitcnt vmcnt(12)
    s_xor_b32 s101, s53, s100
    buffer_load_dwordx4 v[112:115], v1, s[8:11], s101 offen nt
    v_dot2_f32_bf16 v41, v156, v12, 0
    v_add_f32_dpp v40, v40, v40 row_ror:8 row_mask:0xf bank_mask:0xf
    v_dot2_f32_bf16 v41, v157, v13, v41
    s_add_u32 s53, s53, 1024
    v_add_f32_dpp v40, v40, v40 row_ror:4 row_mask:0xf bank_mask:0xf
    v_dot2_f32_bf16 v41, v158, v14, v41
    v_lshlrev_b32 v42, 16, v42
    v_add_f32_dpp v40, v40, v40 row_ror:2 row_mask:0xf bank_mask:0xf
    v_dot2_f32_bf16 v41, v159, v15, v41
    v_max_f32 v28, v28, v42
    v_add_f32_dpp v43, v40, v40 row_ror:1 row_mask:0xf bank_mask:0x4
    s_waitcnt vmcnt(10)
    s_xor_b32 s101, s53, s100
    buffer_load_dwordx4 v[116:119], v1, s[8:11], s101 offen nt
    v_dot2_f32_bf16 v40, v96, v12, 0
    v_add_f32_dpp v41, v41, v41 row_ror:8 row_mask:0xf bank_mask:0xf
    v_dot2_f32_bf16 v40, v97, v13, v40
    s_add_u32 s53, s53, 1024
    v_add_f32_dpp v41, v41, v41 row_ror:4 row_mask:0xf bank_mask:0xf
    v_dot2_f32_bf16 v40, v98, v14, v40
    ds_write_b32 v52, v42 offset:12296
    v_add_f32_dpp v41, v41, v41 row_ror:2 row_mask:0xf bank_mask:0xf
    v_dot2_f32_bf16 v40, v99, v15, v40
    s_nop 0
    v_add_f32_dpp v43, v41, v41 row_ror:1 row_mask:0xf bank_mask:0x8
    s_add_u32 s56, s14, s15
    s_add_u32 s15, s15, 4096
    s_and_b32 s15, s15, 0x7fff
    buffer_load_dwordx4 a[32:35], v3, s[20:23], s56 offen offset:0 nt
    v_mov_b32 v59, 0
    v_mov_b32 v75, s55
    v_mov_b32 v61, 1023
    v_and_b32 v60, 1023, v75
    v_and_b32 v74, 0xffff, v75
    ds_read_b128 v[80:83], v59 offset:8256
    ds_read_b128 v[84:87], v59 offset:8272
    s_lshl_b32 s77, s2, 5
    v_bfe_u32 v65, v77, 5, 1
    v_bfe_u32 v32, v77, 4, 1
    v_lshl_add_u32 v65, v32, 1, v65
    v_and_b32 v32, 3, v77
    v_lshl_add_u32 v65, v32, 2, v65
    v_lshlrev_b32 v68, 4, v65
    s_lshl_b32 s58, s3, 2
    v_add_u32 v67, s58, v68
    v_lshlrev_b32 v66, 2, v65
    v_lshl_add_u32 v65, v65, 1, s77
    buffer_load_ushort v64, v65, s[4:7], 0 offen
    s_waitcnt vmcnt(10)
    s_xor_b32 s101, s53, s100
    buffer_load_dwordx4 v[120:123], v1, s[8:11], s101 offen nt
    v_dot2_f32_bf16 v41, v100, v12, 0
    v_add_f32_dpp v40, v40, v40 row_ror:8 row_mask:0xf bank_mask:0xf
    v_dot2_f32_bf16 v41, v101, v13, v41
    s_add_u32 s53, s53, 1024
    v_add_f32_dpp v40, v40, v40 row_ror:4 row_mask:0xf bank_mask:0xf
    v_dot2_f32_bf16 v41, v102, v14, v41
    v_cvt_pk_bf16_f32 v43, v43, v43
    v_add_f32_dpp v40, v40, v40 row_ror:2 row_mask:0xf bank_mask:0xf
    v_dot2_f32_bf16 v41, v103, v15, v41
    v_lshlrev_b32 v43, 16, v43
    v_add_f32_dpp v42, v40, v40 row_ror:1 row_mask:0xf bank_mask:0x1
    v_lshlrev_b32 v56, 3, v77
    s_lshl_b32 s58, s3, 9
    v_lshl_add_u32 v57, v77, 2, s58
    v_and_b32 v32, 8, v77
    v_lshlrev_b32 v32, 5, v32
    v_and_b32 v58, 0x30, v77
    v_lshl_add_u32 v58, v58, 2, v32
    v_add_u32 v58, s58, v58
    v_mov_b32 v88, v58
    s_lshl_b32 s67, s52, 11
    s_add_u32 s67, s67, s58
    s_add_u32 s67, s67, 65536
    s_mul_i32 s69, s50, 4352
    s_lshl_b32 s59, s51, 4
    s_add_u32 s69, s69, s59
    s_add_u32 s69, s69, 589824
    v_bfe_u32 v63, v77, 5, 1
    v_mul_u32_u24 v63, 4352, v63
    v_bfe_u32 v32, v77, 2, 3
    v_lshl_add_u32 v63, v32, 4, v63
    v_lshrrev_b32 v32, 2, v77
    v_and_b32 v62, 3, v77
    v_lshlrev_b32 v62, 4, v62
    v_lshl_add_u32 v62, v32, 11, v62
    s_mul_i32 s84, s3, 34816
    s_add_u32 s84, s84, 589824
    s_lshl_b32 s76, s2, 6
    s_lshl_b32 s62, s3, 17
    s_add_u32 s62, s62, s76
    s_add_u32 s62, s62, 65536
    s_add_u32 s76, s76, 8192
    s_add_u32 s63, s62, 0x8000
    s_add_u32 s85, s84, 8704
    s_add_u32 s64, s63, 0x8000
    s_add_u32 s86, s85, 8704
    s_add_u32 s65, s64, 0x8000
    s_add_u32 s87, s86, 8704
    s_waitcnt vmcnt(8)
    s_xor_b32 s101, s53, s100
    buffer_load_dwordx4 v[124:127], v1, s[8:11], s101 offen nt
    v_dot2_f32_bf16 v40, v104, v12, 0
    v_add_f32_dpp v41, v41, v41 row_ror:8 row_mask:0xf bank_mask:0xf
    v_dot2_f32_bf16 v40, v105, v13, v40
    s_add_u32 s53, s53, 13312
    v_add_f32_dpp v41, v41, v41 row_ror:4 row_mask:0xf bank_mask:0xf
    v_dot2_f32_bf16 v40, v106, v14, v40
    v_mul_f32 v43, 0x3db504f3, v43
    v_add_f32_dpp v41, v41, v41 row_ror:2 row_mask:0xf bank_mask:0xf
    v_dot2_f32_bf16 v40, v107, v15, v40
    v_cvt_pk_bf16_f32 v43, v43, v43
    v_add_f32_dpp v42, v41, v41 row_ror:1 row_mask:0xf bank_mask:0x2
    buffer_load_dwordx4 a[36:39], v3, s[20:23], s56 offen offset:1024 nt
    v_lshlrev_b32 v72, 16, v72
    s_waitcnt lgkmcnt(0)
    v_add_f32 v80, v80, v82
    v_add_f32 v84, v84, v86
    v_add_f32 v81, v81, v83
    v_add_f32 v85, v85, v87
    v_add_f32 v80, v80, v84
    v_add_f32 v81, v81, v85
    v_cvt_pk_bf16_f32 v80, v80, v80
    v_lshlrev_b32 v80, 16, v80
    v_add_f32 v80, v80, v72
    v_cvt_pk_bf16_f32 v80, v80, v80
    v_lshlrev_b32 v80, 16, v80
    v_or_b32 v80, v80, v74
    v_cvt_pk_bf16_f32 v81, v81, v81
    v_lshlrev_b32 v81, 16, v81
    v_add_f32 v81, v81, v72
    v_cvt_pk_bf16_f32 v81, v81, v81
    v_lshlrev_b32 v81, 16, v81
    v_or_b32 v81, v81, v74
    s_lshl_b32 s58, s52, 3
    s_add_u32 s58, s58, 8192
    s_cmp_lg_u32 s3, 0
    s_cbranch_scc1 L_nob
    s_mov_b64 exec, 1
    buffer_store_dwordx2 v[80:81], v59, s[44:47], s58 offen sc1
    s_mov_b64 exec, -1
L_nob:
    s_waitcnt vmcnt(8)
    s_xor_b32 s101, s53, s100
    buffer_load_dwordx4 v[128:131], v1, s[8:11], s101 offen nt
    v_dot2_f32_bf16 v41, v108, v12, 0
    v_add_f32_dpp v40, v40, v40 row_ror:8 row_mask:0xf bank_mask:0xf
    v_dot2_f32_bf16 v41, v109, v13, v41
    s_add_u32 s53, s53, 1024
    v_add_f32_dpp v40, v40, v40 row_ror:4 row_mask:0xf bank_mask:0xf
    v_dot2_f32_bf16 v41, v110, v14, v41
    v_lshlrev_b32 v43, 16, v43
    v_add_f32_dpp v40, v40, v40 row_ror:2 row_mask:0xf bank_mask:0xf
    v_dot2_f32_bf16 v41, v111, v15, v41
    v_max_f32 v28, v28, v43
    v_add_f32_dpp v42, v40, v40 row_ror:1 row_mask:0xf bank_mask:0x4
    s_and_b32 s72, s2, 7
    s_mul_i32 s72, s72, 4352
    s_add_u32 s72, s72, 729088
    s_lshr_b32 s89, s2, 3
    s_lshl_b32 s89, s89, 2
    s_cmp_eq_u32 s3, 0
    s_cselect_b32 s58, s89, 0x7ff00000
    v_mov_b32 v73, s58
    s_mov_b32 s73, s55
    s_mov_b32 s88, 0
    v_lshlrev_b32 v69, 2, v77
    v_not_b32 v70, v75
    s_cmp_lt_u32 s2, 32
    s_cselect_b32 s90, 0, 0
    s_waitcnt vmcnt(7)
    s_xor_b32 s101, s53, s100
    buffer_load_dwordx4 v[132:135], v1, s[8:11], s101 offen nt
    v_dot2_f32_bf16 v40, v112, v12, 0
    v_add_f32_dpp v41, v41, v41 row_ror:8 row_mask:0xf bank_mask:0xf
    v_dot2_f32_bf16 v40, v113, v13, v40
    s_add_u32 s53, s53, 1024
    v_add_f32_dpp v41, v41, v41 row_ror:4 row_mask:0xf bank_mask:0xf
    v_dot2_f32_bf16 v40, v114, v14, v40
    ds_write_b32 v52, v43 offset:12300
    v_add_f32_dpp v41, v41, v41 row_ror:2 row_mask:0xf bank_mask:0xf
    v_dot2_f32_bf16 v40, v115, v15, v40
    v_add_u32 v52, 0x400, v52
    v_add_f32_dpp v42, v41, v41 row_ror:1 row_mask:0xf bank_mask:0x8
    buffer_load_dwordx4 a[40:43], v3, s[20:23], s56 offen offset:2048 nt
    s_waitcnt vmcnt(8)
    s_xor_b32 s101, s53, s100
    buffer_load_dwordx4 v[136:139], v1, s[8:11], s101 offen nt
    v_dot2_f32_bf16 v41, v116, v12, 0
    v_add_f32_dpp v40, v40, v40 row_ror:8 row_mask:0xf bank_mask:0xf
    v_dot2_f32_bf16 v41, v117, v13, v41
    s_add_u32 s53, s53, 1024
    v_add_f32_dpp v40, v40, v40 row_ror:4 row_mask:0xf bank_mask:0xf
    v_dot2_f32_bf16 v41, v118, v14, v41
    v_cvt_pk_bf16_f32 v42, v42, v42
    v_add_f32_dpp v40, v40, v40 row_ror:2 row_mask:0xf bank_mask:0xf
    v_dot2_f32_bf16 v41, v119, v15, v41
    v_lshlrev_b32 v42, 16, v42
    v_add_f32_dpp v43, v40, v40 row_ror:1 row_mask:0xf bank_mask:0x1
    s_waitcnt vmcnt(6)
    s_xor_b32 s101, s53, s100
    buffer_load_dwordx4 v[140:143], v1, s[8:11], s101 offen nt
    v_dot2_f32_bf16 v40, v120, v12, 0
    v_add_f32_dpp v41, v41, v41 row_ror:8 row_mask:0xf bank_mask:0xf
    v_dot2_f32_bf16 v40, v121, v13, v40
    s_add_u32 s53, s53, 13312
    v_add_f32_dpp v41, v41, v41 row_ror:4 row_mask:0xf bank_mask:0xf
    v_dot2_f32_bf16 v40, v122, v14, v40
    v_mul_f32 v42, 0x3db504f3, v42
    v_add_f32_dpp v41, v41, v41 row_ror:2 row_mask:0xf bank_mask:0xf
    v_dot2_f32_bf16 v40, v123, v15, v40
    v_cvt_pk_bf16_f32 v42, v42, v42
    v_add_f32_dpp v43, v41, v41 row_ror:1 row_mask:0xf bank_mask:0x2
    buffer_load_dwordx4 a[44:47], v3, s[20:23], s56 offen offset:3072 nt
    s_waitcnt vmcnt(7)
    s_xor_b32 s101, s53, s100
    buffer_load_dwordx4 v[144:147], v1, s[8:11], s101 offen nt
    v_dot2_f32_bf16 v41, v124, v12, 0
    v_add_f32_dpp v40, v40, v40 row_ror:8 row_mask:0xf bank_mask:0xf
    v_dot2_f32_bf16 v41, v125, v13, v41
    s_add_u32 s53, s53, 1024
    v_add_f32_dpp v40, v40, v40 row_ror:4 row_mask:0xf bank_mask:0xf
    v_dot2_f32_bf16 v41, v126, v14, v41
    v_lshlrev_b32 v42, 16, v42
    v_add_f32_dpp v40, v40, v40 row_ror:2 row_mask:0xf bank_mask:0xf
    v_dot2_f32_bf16 v41, v127, v15, v41
    v_max_f32 v28, v28, v42
    v_add_f32_dpp v43, v40, v40 row_ror:1 row_mask:0xf bank_mask:0x4
    s_waitcnt vmcnt(6)
    s_xor_b32 s101, s53, s100
    buffer_load_dwordx4 v[148:151], v1, s[8:11], s101 offen nt
    v_dot2_f32_bf16 v40, v128, v12, 0
    v_add_f32_dpp v41, v41, v41 row_ror:8 row_mask:0xf bank_mask:0xf
    v_dot2_f32_bf16 v40, v129, v13, v40
    s_add_u32 s53, s53, 1024
    v_add_f32_dpp v41, v41, v41 row_ror:4 row_mask:0xf bank_mask:0xf
    v_dot2_f32_bf16 v40, v130, v14, v40
    ds_write_b32 v52, v42 offset:12288
    v_add_f32_dpp v41, v41, v41 row_ror:2 row_mask:0xf bank_mask:0xf
    v_dot2_f32_bf16 v40, v131, v15, v40
    s_nop 0
    v_add_f32_dpp v43, v41, v41 row_ror:1 row_mask:0xf bank_mask:0x8
    s_add_u32 s56, s14, s15
    s_add_u32 s15, s15, 4096
    s_and_b32 s15, s15, 0x7fff
    buffer_load_dwordx4 a[48:51], v3, s[20:23], s56 offen offset:0 nt
    s_waitcnt vmcnt(12)
    v_lshlrev_b32 v64, 16, v64
    s_waitcnt vmcnt(7)
    s_xor_b32 s101, s53, s100
    buffer_load_dwordx4 v[152:155], v1, s[8:11], s101 offen nt
    v_dot2_f32_bf16 v41, v132, v12, 0
    v_add_f32_dpp v40, v40, v40 row_ror:8 row_mask:0xf bank_mask:0xf
    v_dot2_f32_bf16 v41, v133, v13, v41
    s_add_u32 s53, s53, 1024
    v_add_f32_dpp v40, v40, v40 row_ror:4 row_mask:0xf bank_mask:0xf
    v_dot2_f32_bf16 v41, v134, v14, v41
    v_cvt_pk_bf16_f32 v43, v43, v43
    v_add_f32_dpp v40, v40, v40 row_ror:2 row_mask:0xf bank_mask:0xf
    v_dot2_f32_bf16 v41, v135, v15, v41
    v_lshlrev_b32 v43, 16, v43
    v_add_f32_dpp v42, v40, v40 row_ror:1 row_mask:0xf bank_mask:0x1
    s_waitcnt vmcnt(6)
    s_xor_b32 s101, s53, s100
    buffer_load_dwordx4 v[156:159], v1, s[8:11], s101 offen nt
    v_dot2_f32_bf16 v40, v136, v12, 0
    v_add_f32_dpp v41, v41, v41 row_ror:8 row_mask:0xf bank_mask:0xf
    v_dot2_f32_bf16 v40, v137, v13, v40
    s_add_u32 s53, s53, 13312
    v_add_f32_dpp v41, v41, v41 row_ror:4 row_mask:0xf bank_mask:0xf
    v_dot2_f32_bf16 v40, v138, v14, v40
    v_mul_f32 v43, 0x3db504f3, v43
    v_add_f32_dpp v41, v41, v41 row_ror:2 row_mask:0xf bank_mask:0xf
    v_dot2_f32_bf16 v40, v139, v15, v40
    v_cvt_pk_bf16_f32 v43, v43, v43
    v_add_f32_dpp v42, v41, v41 row_ror:1 row_mask:0xf bank_mask:0x2
    buffer_load_dwordx4 a[52:55], v3, s[20:23], s56 offen offset:1024 nt
    s_waitcnt vmcnt(7)
    s_xor_b32 s101, s53, s100
    buffer_load_dwordx4 v[96:99], v1, s[8:11], s101 offen nt
    v_dot2_f32_bf16 v41, v140, v12, 0
    v_add_f32_dpp v40, v40, v40 row_ror:8 row_mask:0xf bank_mask:0xf
    v_dot2_f32_bf16 v41, v141, v13, v41
    s_add_u32 s53, s53, 1024
    v_add_f32_dpp v40, v40, v40 row_ror:4 row_mask:0xf bank_mask:0xf
    v_dot2_f32_bf16 v41, v142, v14, v41
    v_lshlrev_b32 v43, 16, v43
    v_add_f32_dpp v40, v40, v40 row_ror:2 row_mask:0xf bank_mask:0xf
    v_dot2_f32_bf16 v41, v143, v15, v41
    v_max_f32 v28, v28, v43
    v_add_f32_dpp v42, v40, v40 row_ror:1 row_mask:0xf bank_mask:0x4
    s_waitcnt vmcnt(6)
    s_xor_b32 s101, s53, s100
    buffer_load_dwordx4 v[100:103], v1, s[8:11], s101 offen nt
    v_dot2_f32_bf16 v40, v144, v12, 0
    v_add_f32_dpp v41, v41, v41 row_ror:8 row_mask:0xf bank_mask:0xf
    v_dot2_f32_bf16 v40, v145, v13, v40
    s_add_u32 s53, s53, 1024
    v_add_f32_dpp v41, v41, v41 row_ror:4 row_mask:0xf bank_mask:0xf
    v_dot2_f32_bf16 v40, v146, v14, v40
    ds_write_b32 v52, v43 offset:12292
    v_add_f32_dpp v41, v41, v41 row_ror:2 row_mask:0xf bank_mask:0xf
    v_dot2_f32_bf16 v40, v147, v15, v40
    s_nop 0
    v_add_f32_dpp v42, v41, v41 row_ror:1 row_mask:0xf bank_mask:0x8
    buffer_load_dwordx4 a[56:59], v3, s[20:23], s56 offen offset:2048 nt
    s_waitcnt vmcnt(7)
    s_xor_b32 s101, s53, s100
    buffer_load_dwordx4 v[104:107], v1, s[8:11], s101 offen nt
    v_dot2_f32_bf16 v41, v148, v12, 0
    v_add_f32_dpp v40, v40, v40 row_ror:8 row_mask:0xf bank_mask:0xf
    v_dot2_f32_bf16 v41, v149, v13, v41
    s_add_u32 s53, s53, 1024
    v_add_f32_dpp v40, v40, v40 row_ror:4 row_mask:0xf bank_mask:0xf
    v_dot2_f32_bf16 v41, v150, v14, v41
    v_cvt_pk_bf16_f32 v42, v42, v42
    v_add_f32_dpp v40, v40, v40 row_ror:2 row_mask:0xf bank_mask:0xf
    v_dot2_f32_bf16 v41, v151, v15, v41
    v_lshlrev_b32 v42, 16, v42
    v_add_f32_dpp v43, v40, v40 row_ror:1 row_mask:0xf bank_mask:0x1
    s_waitcnt vmcnt(6)
    s_xor_b32 s101, s53, s100
    buffer_load_dwordx4 v[108:111], v1, s[8:11], s101 offen nt
    v_dot2_f32_bf16 v40, v152, v12, 0
    v_add_f32_dpp v41, v41, v41 row_ror:8 row_mask:0xf bank_mask:0xf
    v_dot2_f32_bf16 v40, v153, v13, v40
    s_add_u32 s53, s53, 13312
    v_add_f32_dpp v41, v41, v41 row_ror:4 row_mask:0xf bank_mask:0xf
    v_dot2_f32_bf16 v40, v154, v14, v40
    v_mul_f32 v42, 0x3db504f3, v42
    v_add_f32_dpp v41, v41, v41 row_ror:2 row_mask:0xf bank_mask:0xf
    v_dot2_f32_bf16 v40, v155, v15, v40
    v_cvt_pk_bf16_f32 v42, v42, v42
    v_add_f32_dpp v43, v41, v41 row_ror:1 row_mask:0xf bank_mask:0x2
    buffer_load_dwordx4 a[60:63], v3, s[20:23], s56 offen offset:3072 nt
    s_waitcnt vmcnt(7)
    s_xor_b32 s101, s53, s100
    buffer_load_dwordx4 v[112:115], v1, s[8:11], s101 offen nt
    v_dot2_f32_bf16 v41, v156, v12, 0
    v_add_f32_dpp v40, v40, v40 row_ror:8 row_mask:0xf bank_mask:0xf
    v_dot2_f32_bf16 v41, v157, v13, v41
    s_add_u32 s53, s53, 1024
    v_add_f32_dpp v40, v40, v40 row_ror:4 row_mask:0xf bank_mask:0xf
    v_dot2_f32_bf16 v41, v158, v14, v41
    v_lshlrev_b32 v42, 16, v42
    v_add_f32_dpp v40, v40, v40 row_ror:2 row_mask:0xf bank_mask:0xf
    v_dot2_f32_bf16 v41, v159, v15, v41
    v_max_f32 v28, v28, v42
    v_add_f32_dpp v43, v40, v40 row_ror:1 row_mask:0xf bank_mask:0x4
    s_waitcnt vmcnt(6)
    s_xor_b32 s101, s53, s100
    buffer_load_dwordx4 v[116:119], v1, s[8:11], s101 offen nt
    v_dot2_f32_bf16 v40, v96, v12, 0
    v_add_f32_dpp v41, v41, v41 row_ror:8 row_mask:0xf bank_mask:0xf
    v_dot2_f32_bf16 v40, v97, v13, v40
    s_add_u32 s53, s53, 1024
    v_add_f32_dpp v41, v41, v41 row_ror:4 row_mask:0xf bank_mask:0xf
    v_dot2_f32_bf16 v40, v98, v14, v40
    ds_write_b32 v52, v42 offset:12296
    v_add_f32_dpp v41, v41, v41 row_ror:2 row_mask:0xf bank_mask:0xf
    v_dot2_f32_bf16 v40, v99, v15, v40
    s_nop 0
    v_add_f32_dpp v43, v41, v41 row_ror:1 row_mask:0xf bank_mask:0x8
    s_add_u32 s56, s14, s15
    s_add_u32 s15, s15, 4096
    s_and_b32 s15, s15, 0x7fff
    buffer_load_dwordx4 a[64:67], v3, s[20:23], s56 offen offset:0 nt
    s_waitcnt vmcnt(7)
    s_xor_b32 s101, s53, s100
    buffer_load_dwordx4 v[120:123], v1, s[8:11], s101 offen nt
    v_dot2_f32_bf16 v41, v100, v12, 0
    v_add_f32_dpp v40, v40, v40 row_ror:8 row_mask:0xf bank_mask:0xf
    v_dot2_f32_bf16 v41, v101, v13, v41
    s_add_u32 s53, s53, 1024
    v_add_f32_dpp v40, v40, v40 row_ror:4 row_mask:0xf bank_mask:0xf
    v_dot2_f32_bf16 v41, v102, v14, v41
    v_cvt_pk_bf16_f32 v43, v43, v43
    v_add_f32_dpp v40, v40, v40 row_ror:2 row_mask:0xf bank_mask:0xf
    v_dot2_f32_bf16 v41, v103, v15, v41
    v_lshlrev_b32 v43, 16, v43
    v_add_f32_dpp v42, v40, v40 row_ror:1 row_mask:0xf bank_mask:0x1
    s_waitcnt vmcnt(6)
    s_xor_b32 s101, s53, s100
    buffer_load_dwordx4 v[124:127], v1, s[8:11], s101 offen nt
    v_dot2_f32_bf16 v40, v104, v12, 0
    v_add_f32_dpp v41, v41, v41 row_ror:8 row_mask:0xf bank_mask:0xf
    v_dot2_f32_bf16 v40, v105, v13, v40
    s_add_u32 s53, s53, 13312
    v_add_f32_dpp v41, v41, v41 row_ror:4 row_mask:0xf bank_mask:0xf
    v_dot2_f32_bf16 v40, v106, v14, v40
    v_mul_f32 v43, 0x3db504f3, v43
    v_add_f32_dpp v41, v41, v41 row_ror:2 row_mask:0xf bank_mask:0xf
    v_dot2_f32_bf16 v40, v107, v15, v40
    v_cvt_pk_bf16_f32 v43, v43, v43
    v_add_f32_dpp v42, v41, v41 row_ror:1 row_mask:0xf bank_mask:0x2
    buffer_load_dwordx4 a[68:71], v3, s[20:23], s56 offen offset:1024 nt
    s_waitcnt vmcnt(7)
    s_xor_b32 s101, s53, s100
    buffer_load_dwordx4 v[128:131], v1, s[8:11], s101 offen nt
    v_dot2_f32_bf16 v41, v108, v12, 0
    v_add_f32_dpp v40, v40, v40 row_ror:8 row_mask:0xf bank_mask:0xf
    v_dot2_f32_bf16 v41, v109, v13, v41
    s_add_u32 s53, s53, 1024
    v_add_f32_dpp v40, v40, v40 row_ror:4 row_mask:0xf bank_mask:0xf
    v_dot2_f32_bf16 v41, v110, v14, v41
    v_lshlrev_b32 v43, 16, v43
    v_add_f32_dpp v40, v40, v40 row_ror:2 row_mask:0xf bank_mask:0xf
    v_dot2_f32_bf16 v41, v111, v15, v41
    v_max_f32 v28, v28, v43
    v_add_f32_dpp v42, v40, v40 row_ror:1 row_mask:0xf bank_mask:0x4
    s_waitcnt vmcnt(6)
    s_xor_b32 s101, s53, s100
    buffer_load_dwordx4 v[132:135], v1, s[8:11], s101 offen nt
    v_dot2_f32_bf16 v40, v112, v12, 0
    v_add_f32_dpp v41, v41, v41 row_ror:8 row_mask:0xf bank_mask:0xf
    v_dot2_f32_bf16 v40, v113, v13, v40
    s_add_u32 s53, s53, 1024
    v_add_f32_dpp v41, v41, v41 row_ror:4 row_mask:0xf bank_mask:0xf
    v_dot2_f32_bf16 v40, v114, v14, v40
    ds_write_b32 v52, v43 offset:12300
    v_add_f32_dpp v41, v41, v41 row_ror:2 row_mask:0xf bank_mask:0xf
    v_dot2_f32_bf16 v40, v115, v15, v40
    v_add_u32 v52, 0x400, v52
    v_add_f32_dpp v42, v41, v41 row_ror:1 row_mask:0xf bank_mask:0x8
    buffer_load_dwordx4 a[72:75], v3, s[20:23], s56 offen offset:2048 nt
    s_waitcnt vmcnt(7)
    s_xor_b32 s101, s53, s100
    buffer_load_dwordx4 v[136:139], v1, s[8:11], s101 offen nt
    v_dot2_f32_bf16 v41, v116, v12, 0
    v_add_f32_dpp v40, v40, v40 row_ror:8 row_mask:0xf bank_mask:0xf
    v_dot2_f32_bf16 v41, v117, v13, v41
    s_add_u32 s53, s53, 1024
    v_add_f32_dpp v40, v40, v40 row_ror:4 row_mask:0xf bank_mask:0xf
    v_dot2_f32_bf16 v41, v118, v14, v41
    v_cvt_pk_bf16_f32 v42, v42, v42
    v_add_f32_dpp v40, v40, v40 row_ror:2 row_mask:0xf bank_mask:0xf
    v_dot2_f32_bf16 v41, v119, v15, v41
    v_lshlrev_b32 v42, 16, v42
    v_add_f32_dpp v43, v40, v40 row_ror:1 row_mask:0xf bank_mask:0x1
    s_waitcnt vmcnt(6)
    s_xor_b32 s101, s53, s100
    buffer_load_dwordx4 v[140:143], v1, s[8:11], s101 offen nt
    v_dot2_f32_bf16 v40, v120, v12, 0
    v_add_f32_dpp v41, v41, v41 row_ror:8 row_mask:0xf bank_mask:0xf
    v_dot2_f32_bf16 v40, v121, v13, v40
    s_add_u32 s53, s53, 13312
    v_add_f32_dpp v41, v41, v41 row_ror:4 row_mask:0xf bank_mask:0xf
    v_dot2_f32_bf16 v40, v122, v14, v40
    v_mul_f32 v42, 0x3db504f3, v42
    v_add_f32_dpp v41, v41, v41 row_ror:2 row_mask:0xf bank_mask:0xf
    v_dot2_f32_bf16 v40, v123, v15, v40
    v_cvt_pk_bf16_f32 v42, v42, v42
    v_add_f32_dpp v43, v41, v41 row_ror:1 row_mask:0xf bank_mask:0x2
    buffer_load_dwordx4 a[76:79], v3, s[20:23], s56 offen offset:3072 nt
    s_waitcnt vmcnt(7)
    s_xor_b32 s101, s53, s100
    buffer_load_dwordx4 v[144:147], v1, s[8:11], s101 offen nt
    v_dot2_f32_bf16 v41, v124, v12, 0
    v_add_f32_dpp v40, v40, v40 row_ror:8 row_mask:0xf bank_mask:0xf
    v_dot2_f32_bf16 v41, v125, v13, v41
    s_add_u32 s53, s53, 1024
    v_add_f32_dpp v40, v40, v40 row_ror:4 row_mask:0xf bank_mask:0xf
    v_dot2_f32_bf16 v41, v126, v14, v41
    v_lshlrev_b32 v42, 16, v42
    v_add_f32_dpp v40, v40, v40 row_ror:2 row_mask:0xf bank_mask:0xf
    v_dot2_f32_bf16 v41, v127, v15, v41
    v_max_f32 v28, v28, v42
    v_add_f32_dpp v43, v40, v40 row_ror:1 row_mask:0xf bank_mask:0x4
    s_waitcnt vmcnt(6)
    s_xor_b32 s101, s53, s100
    buffer_load_dwordx4 v[148:151], v1, s[8:11], s101 offen nt
    v_dot2_f32_bf16 v40, v128, v12, 0
    v_add_f32_dpp v41, v41, v41 row_ror:8 row_mask:0xf bank_mask:0xf
    v_dot2_f32_bf16 v40, v129, v13, v40
    s_add_u32 s53, s53, 1024
    v_add_f32_dpp v41, v41, v41 row_ror:4 row_mask:0xf bank_mask:0xf
    v_dot2_f32_bf16 v40, v130, v14, v40
    ds_write_b32 v52, v42 offset:12288
    v_add_f32_dpp v41, v41, v41 row_ror:2 row_mask:0xf bank_mask:0xf
    v_dot2_f32_bf16 v40, v131, v15, v40
    s_nop 0
    v_add_f32_dpp v43, v41, v41 row_ror:1 row_mask:0xf bank_mask:0x8
    s_add_u32 s56, s14, s15
    s_add_u32 s15, s15, 4096
    s_and_b32 s15, s15, 0x7fff
    buffer_load_dwordx4 a[80:83], v3, s[20:23], s56 offen offset:0 nt
    s_waitcnt vmcnt(7)
    s_xor_b32 s101, s53, s100
    buffer_load_dwordx4 v[152:155], v1, s[8:11], s101 offen nt
    v_dot2_f32_bf16 v41, v132, v12, 0
    v_add_f32_dpp v40, v40, v40 row_ror:8 row_mask:0xf bank_mask:0xf
    v_dot2_f32_bf16 v41, v133, v13, v41
    s_add_u32 s53, s53, 1024
    v_add_f32_dpp v40, v40, v40 row_ror:4 row_mask:0xf bank_mask:0xf
    v_dot2_f32_bf16 v41, v134, v14, v41
    v_cvt_pk_bf16_f32 v43, v43, v43
    v_add_f32_dpp v40, v40, v40 row_ror:2 row_mask:0xf bank_mask:0xf
    v_dot2_f32_bf16 v41, v135, v15, v41
    v_lshlrev_b32 v43, 16, v43
    v_add_f32_dpp v42, v40, v40 row_ror:1 row_mask:0xf bank_mask:0x1
    s_waitcnt vmcnt(6)
    s_xor_b32 s101, s53, s100
    buffer_load_dwordx4 v[156:159], v1, s[8:11], s101 offen nt
    v_dot2_f32_bf16 v40, v136, v12, 0
    v_add_f32_dpp v41, v41, v41 row_ror:8 row_mask:0xf bank_mask:0xf
    v_dot2_f32_bf16 v40, v137, v13, v40
    s_add_u32 s53, s53, 13312
    v_add_f32_dpp v41, v41, v41 row_ror:4 row_mask:0xf bank_mask:0xf
    v_dot2_f32_bf16 v40, v138, v14, v40
    v_mul_f32 v43, 0x3db504f3, v43
    v_add_f32_dpp v41, v41, v41 row_ror:2 row_mask:0xf bank_mask:0xf
    v_dot2_f32_bf16 v40, v139, v15, v40
    v_cvt_pk_bf16_f32 v43, v43, v43
    v_add_f32_dpp v42, v41, v41 row_ror:1 row_mask:0xf bank_mask:0x2
    buffer_load_dwordx4 a[84:87], v3, s[20:23], s56 offen offset:1024 nt
    s_waitcnt vmcnt(7)
    s_xor_b32 s101, s53, s100
    buffer_load_dwordx4 v[96:99], v1, s[8:11], s101 offen nt
    v_dot2_f32_bf16 v41, v140, v12, 0
    v_add_f32_dpp v40, v40, v40 row_ror:8 row_mask:0xf bank_mask:0xf
    v_dot2_f32_bf16 v41, v141, v13, v41
    s_add_u32 s53, s53, 1024
    v_add_f32_dpp v40, v40, v40 row_ror:4 row_mask:0xf bank_mask:0xf
    v_dot2_f32_bf16 v41, v142, v14, v41
    v_lshlrev_b32 v43, 16, v43
    v_add_f32_dpp v40, v40, v40 row_ror:2 row_mask:0xf bank_mask:0xf
    v_dot2_f32_bf16 v41, v143, v15, v41
    v_max_f32 v28, v28, v43
    v_add_f32_dpp v42, v40, v40 row_ror:1 row_mask:0xf bank_mask:0x4
    s_waitcnt vmcnt(6)
    s_xor_b32 s101, s53, s100
    buffer_load_dwordx4 v[100:103], v1, s[8:11], s101 offen nt
    v_dot2_f32_bf16 v40, v144, v12, 0
    v_add_f32_dpp v41, v41, v41 row_ror:8 row_mask:0xf bank_mask:0xf
    v_dot2_f32_bf16 v40, v145, v13, v40
    s_add_u32 s53, s53, 1024
    v_add_f32_dpp v41, v41, v41 row_ror:4 row_mask:0xf bank_mask:0xf
    v_dot2_f32_bf16 v40, v146, v14, v40
    ds_write_b32 v52, v43 offset:12292
    v_add_f32_dpp v41, v41, v41 row_ror:2 row_mask:0xf bank_mask:0xf
    v_dot2_f32_bf16 v40, v147, v15, v40
    s_nop 0
    v_add_f32_dpp v42, v41, v41 row_ror:1 row_mask:0xf bank_mask:0x8
    buffer_load_dwordx4 a[88:91], v3, s[20:23], s56 offen offset:2048 nt
    s_waitcnt vmcnt(7)
    s_xor_b32 s101, s53, s100
    buffer_load_dwordx4 v[104:107], v1, s[8:11], s101 offen nt
    v_dot2_f32_bf16 v41, v148, v12, 0
    v_add_f32_dpp v40, v40, v40 row_ror:8 row_mask:0xf bank_mask:0xf
    v_dot2_f32_bf16 v41, v149, v13, v41
    s_add_u32 s53, s53, 1024
    v_add_f32_dpp v40, v40, v40 row_ror:4 row_mask:0xf bank_mask:0xf
    v_dot2_f32_bf16 v41, v150, v14, v41
    v_cvt_pk_bf16_f32 v42, v42, v42
    v_add_f32_dpp v40, v40, v40 row_ror:2 row_mask:0xf bank_mask:0xf
    v_dot2_f32_bf16 v41, v151, v15, v41
    v_lshlrev_b32 v42, 16, v42
    v_add_f32_dpp v43, v40, v40 row_ror:1 row_mask:0xf bank_mask:0x1
    s_waitcnt vmcnt(6)
    s_xor_b32 s101, s53, s100
    buffer_load_dwordx4 v[108:111], v1, s[8:11], s101 offen nt
    v_dot2_f32_bf16 v40, v152, v12, 0
    v_add_f32_dpp v41, v41, v41 row_ror:8 row_mask:0xf bank_mask:0xf
    v_dot2_f32_bf16 v40, v153, v13, v40
    s_add_u32 s53, s53, 13312
    v_add_f32_dpp v41, v41, v41 row_ror:4 row_mask:0xf bank_mask:0xf
    v_dot2_f32_bf16 v40, v154, v14, v40
    v_mul_f32 v42, 0x3db504f3, v42
    v_add_f32_dpp v41, v41, v41 row_ror:2 row_mask:0xf bank_mask:0xf
    v_dot2_f32_bf16 v40, v155, v15, v40
    v_cvt_pk_bf16_f32 v42, v42, v42
    v_add_f32_dpp v43, v41, v41 row_ror:1 row_mask:0xf bank_mask:0x2
    buffer_load_dwordx4 a[92:95], v3, s[20:23], s56 offen offset:3072 nt
    s_waitcnt vmcnt(7)
    s_xor_b32 s101, s53, s100
    buffer_load_dwordx4 v[112:115], v1, s[8:11], s101 offen nt
    v_dot2_f32_bf16 v41, v156, v12, 0
    v_add_f32_dpp v40, v40, v40 row_ror:8 row_mask:0xf bank_mask:0xf
    v_dot2_f32_bf16 v41, v157, v13, v41
    s_add_u32 s53, s53, 1024
    v_add_f32_dpp v40, v40, v40 row_ror:4 row_mask:0xf bank_mask:0xf
    v_dot2_f32_bf16 v41, v158, v14, v41
    v_lshlrev_b32 v42, 16, v42
    v_add_f32_dpp v40, v40, v40 row_ror:2 row_mask:0xf bank_mask:0xf
    v_dot2_f32_bf16 v41, v159, v15, v41
    v_max_f32 v28, v28, v42
    v_add_f32_dpp v43, v40, v40 row_ror:1 row_mask:0xf bank_mask:0x4
    s_waitcnt vmcnt(6)
    s_xor_b32 s101, s53, s100
    buffer_load_dwordx4 v[116:119], v1, s[8:11], s101 offen nt
    v_dot2_f32_bf16 v40, v96, v12, 0
    v_add_f32_dpp v41, v41, v41 row_ror:8 row_mask:0xf bank_mask:0xf
    v_dot2_f32_bf16 v40, v97, v13, v40
    s_add_u32 s53, s53, 1024
    v_add_f32_dpp v41, v41, v41 row_ror:4 row_mask:0xf bank_mask:0xf
    v_dot2_f32_bf16 v40, v98, v14, v40
    ds_write_b32 v52, v42 offset:12296
    v_add_f32_dpp v41, v41, v41 row_ror:2 row_mask:0xf bank_mask:0xf
    v_dot2_f32_bf16 v40, v99, v15, v40
    s_nop 0
    v_add_f32_dpp v43, v41, v41 row_ror:1 row_mask:0xf bank_mask:0x8
    s_add_u32 s56, s14, s15
    s_add_u32 s15, s15, 4096
    s_and_b32 s15, s15, 0x7fff
    buffer_load_dwordx4 a[96:99], v3, s[20:23], s56 offen offset:0 nt
    s_waitcnt vmcnt(7)
    s_xor_b32 s101, s53, s100
    buffer_load_dwordx4 v[120:123], v1, s[8:11], s101 offen nt
    v_dot2_f32_bf16 v41, v100, v12, 0
    v_add_f32_dpp v40, v40, v40 row_ror:8 row_mask:0xf bank_mask:0xf
    v_dot2_f32_bf16 v41, v101, v13, v41
    s_add_u32 s53, s53, 1024
    v_add_f32_dpp v40, v40, v40 row_ror:4 row_mask:0xf bank_mask:0xf
    v_dot2_f32_bf16 v41, v102, v14, v41
    v_cvt_pk_bf16_f32 v43, v43, v43
    v_add_f32_dpp v40, v40, v40 row_ror:2 row_mask:0xf bank_mask:0xf
    v_dot2_f32_bf16 v41, v103, v15, v41
    v_lshlrev_b32 v43, 16, v43
    v_add_f32_dpp v42, v40, v40 row_ror:1 row_mask:0xf bank_mask:0x1
    s_waitcnt vmcnt(6)
    s_xor_b32 s101, s53, s100
    buffer_load_dwordx4 v[124:127], v1, s[8:11], s101 offen nt
    v_dot2_f32_bf16 v40, v104, v12, 0
    v_add_f32_dpp v41, v41, v41 row_ror:8 row_mask:0xf bank_mask:0xf
    v_dot2_f32_bf16 v40, v105, v13, v40
    s_add_u32 s53, s53, 13312
    v_add_f32_dpp v41, v41, v41 row_ror:4 row_mask:0xf bank_mask:0xf
    v_dot2_f32_bf16 v40, v106, v14, v40
    v_mul_f32 v43, 0x3db504f3, v43
    v_add_f32_dpp v41, v41, v41 row_ror:2 row_mask:0xf bank_mask:0xf
    v_dot2_f32_bf16 v40, v107, v15, v40
    v_cvt_pk_bf16_f32 v43, v43, v43
    v_add_f32_dpp v42, v41, v41 row_ror:1 row_mask:0xf bank_mask:0x2
    buffer_load_dwordx4 a[100:103], v3, s[20:23], s56 offen offset:1024 nt
    s_waitcnt vmcnt(7)
    s_xor_b32 s101, s53, s100
    buffer_load_dwordx4 v[128:131], v1, s[8:11], s101 offen nt
    v_dot2_f32_bf16 v41, v108, v12, 0
    v_add_f32_dpp v40, v40, v40 row_ror:8 row_mask:0xf bank_mask:0xf
    v_dot2_f32_bf16 v41, v109, v13, v41
    s_add_u32 s53, s53, 1024
    v_add_f32_dpp v40, v40, v40 row_ror:4 row_mask:0xf bank_mask:0xf
    v_dot2_f32_bf16 v41, v110, v14, v41
    v_lshlrev_b32 v43, 16, v43
    v_add_f32_dpp v40, v40, v40 row_ror:2 row_mask:0xf bank_mask:0xf
    v_dot2_f32_bf16 v41, v111, v15, v41
    v_max_f32 v28, v28, v43
    v_add_f32_dpp v42, v40, v40 row_ror:1 row_mask:0xf bank_mask:0x4
    s_waitcnt vmcnt(6)
    s_xor_b32 s101, s53, s100
    buffer_load_dwordx4 v[132:135], v1, s[8:11], s101 offen nt
    v_dot2_f32_bf16 v40, v112, v12, 0
    v_add_f32_dpp v41, v41, v41 row_ror:8 row_mask:0xf bank_mask:0xf
    v_dot2_f32_bf16 v40, v113, v13, v40
    s_add_u32 s53, s53, 1024
    v_add_f32_dpp v41, v41, v41 row_ror:4 row_mask:0xf bank_mask:0xf
    v_dot2_f32_bf16 v40, v114, v14, v40
    ds_write_b32 v52, v43 offset:12300
    v_add_f32_dpp v41, v41, v41 row_ror:2 row_mask:0xf bank_mask:0xf
    v_dot2_f32_bf16 v40, v115, v15, v40
    v_add_u32 v52, 0x400, v52
    v_add_f32_dpp v42, v41, v41 row_ror:1 row_mask:0xf bank_mask:0x8
    buffer_load_dwordx4 a[104:107], v3, s[20:23], s56 offen offset:2048 nt
    s_waitcnt vmcnt(7)
    s_xor_b32 s101, s53, s100
    buffer_load_dwordx4 v[136:139], v1, s[8:11], s101 offen nt
    v_dot2_f32_bf16 v41, v116, v12, 0
    v_add_f32_dpp v40, v40, v40 row_ror:8 row_mask:0xf bank_mask:0xf
    v_dot2_f32_bf16 v41, v117, v13, v41
    s_add_u32 s53, s53, 1024
    v_add_f32_dpp v40, v40, v40 row_ror:4 row_mask:0xf bank_mask:0xf
    v_dot2_f32_bf16 v41, v118, v14, v41
    v_cvt_pk_bf16_f32 v42, v42, v42
    v_add_f32_dpp v40, v40, v40 row_ror:2 row_mask:0xf bank_mask:0xf
    v_dot2_f32_bf16 v41, v119, v15, v41
    v_lshlrev_b32 v42, 16, v42
    v_add_f32_dpp v43, v40, v40 row_ror:1 row_mask:0xf bank_mask:0x1
    s_waitcnt vmcnt(6)
    s_xor_b32 s101, s53, s100
    buffer_load_dwordx4 v[140:143], v1, s[8:11], s101 offen nt
    v_dot2_f32_bf16 v40, v120, v12, 0
    v_add_f32_dpp v41, v41, v41 row_ror:8 row_mask:0xf bank_mask:0xf
    v_dot2_f32_bf16 v40, v121, v13, v40
    s_add_u32 s53, s53, 13312
    v_add_f32_dpp v41, v41, v41 row_ror:4 row_mask:0xf bank_mask:0xf
    v_dot2_f32_bf16 v40, v122, v14, v40
    v_mul_f32 v42, 0x3db504f3, v42
    v_add_f32_dpp v41, v41, v41 row_ror:2 row_mask:0xf bank_mask:0xf
    v_dot2_f32_bf16 v40, v123, v15, v40
    v_cvt_pk_bf16_f32 v42, v42, v42
    v_add_f32_dpp v43, v41, v41 row_ror:1 row_mask:0xf bank_mask:0x2
    buffer_load_dwordx4 a[108:111], v3, s[20:23], s56 offen offset:3072 nt
    s_waitcnt vmcnt(7)
    s_xor_b32 s101, s53, s100
    buffer_load_dwordx4 v[144:147], v1, s[8:11], s101 offen nt
    v_dot2_f32_bf16 v41, v124, v12, 0
    v_add_f32_dpp v40, v40, v40 row_ror:8 row_mask:0xf bank_mask:0xf
    v_dot2_f32_bf16 v41, v125, v13, v41
    s_add_u32 s53, s53, 1024
    v_add_f32_dpp v40, v40, v40 row_ror:4 row_mask:0xf bank_mask:0xf
    v_dot2_f32_bf16 v41, v126, v14, v41
    v_lshlrev_b32 v42, 16, v42
    v_add_f32_dpp v40, v40, v40 row_ror:2 row_mask:0xf bank_mask:0xf
    v_dot2_f32_bf16 v41, v127, v15, v41
    v_max_f32 v28, v28, v42
    v_add_f32_dpp v43, v40, v40 row_ror:1 row_mask:0xf bank_mask:0x4
    s_waitcnt vmcnt(6)
    s_xor_b32 s101, s53, s100
    buffer_load_dwordx4 v[148:151], v1, s[8:11], s101 offen nt
    v_dot2_f32_bf16 v40, v128, v12, 0
    v_add_f32_dpp v41, v41, v41 row_ror:8 row_mask:0xf bank_mask:0xf
    v_dot2_f32_bf16 v40, v129, v13, v40
    s_add_u32 s53, s53, 1024
    v_add_f32_dpp v41, v41, v41 row_ror:4 row_mask:0xf bank_mask:0xf
    v_dot2_f32_bf16 v40, v130, v14, v40
    ds_write_b32 v52, v42 offset:12288
    v_add_f32_dpp v41, v41, v41 row_ror:2 row_mask:0xf bank_mask:0xf
    v_dot2_f32_bf16 v40, v131, v15, v40
    s_nop 0
    v_add_f32_dpp v43, v41, v41 row_ror:1 row_mask:0xf bank_mask:0x8
    s_add_u32 s56, s14, s15
    s_add_u32 s15, s15, 4096
    s_and_b32 s15, s15, 0x7fff
    buffer_load_dwordx4 a[112:115], v3, s[20:23], s56 offen offset:0 nt
    s_waitcnt vmcnt(7)
    s_xor_b32 s101, s53, s100
    buffer_load_dwordx4 v[152:155], v1, s[8:11], s101 offen nt
    v_dot2_f32_bf16 v41, v132, v12, 0
    v_add_f32_dpp v40, v40, v40 row_ror:8 row_mask:0xf bank_mask:0xf
    v_dot2_f32_bf16 v41, v133, v13, v41
    s_add_u32 s53, s53, 1024
    v_add_f32_dpp v40, v40, v40 row_ror:4 row_mask:0xf bank_mask:0xf
    v_dot2_f32_bf16 v41, v134, v14, v41
    v_cvt_pk_bf16_f32 v43, v43, v43
    v_add_f32_dpp v40, v40, v40 row_ror:2 row_mask:0xf bank_mask:0xf
    v_dot2_f32_bf16 v41, v135, v15, v41
    v_lshlrev_b32 v43, 16, v43
    v_add_f32_dpp v42, v40, v40 row_ror:1 row_mask:0xf bank_mask:0x1
    s_waitcnt vmcnt(6)
    s_xor_b32 s101, s53, s100
    buffer_load_dwordx4 v[156:159], v1, s[8:11], s101 offen nt
    v_dot2_f32_bf16 v40, v136, v12, 0
    v_add_f32_dpp v41, v41, v41 row_ror:8 row_mask:0xf bank_mask:0xf
    v_dot2_f32_bf16 v40, v137, v13, v40
    s_add_u32 s53, s53, 13312
    v_add_f32_dpp v41, v41, v41 row_ror:4 row_mask:0xf bank_mask:0xf
    v_dot2_f32_bf16 v40, v138, v14, v40
    v_mul_f32 v43, 0x3db504f3, v43
    v_add_f32_dpp v41, v41, v41 row_ror:2 row_mask:0xf bank_mask:0xf
    v_dot2_f32_bf16 v40, v139, v15, v40
    v_cvt_pk_bf16_f32 v43, v43, v43
    v_add_f32_dpp v42, v41, v41 row_ror:1 row_mask:0xf bank_mask:0x2
    buffer_load_dwordx4 a[116:119], v3, s[20:23], s56 offen offset:1024 nt
    s_waitcnt vmcnt(7)
    s_xor_b32 s101, s53, s100
    buffer_load_dwordx4 v[96:99], v1, s[8:11], s101 offen nt
    v_dot2_f32_bf16 v41, v140, v12, 0
    v_add_f32_dpp v40, v40, v40 row_ror:8 row_mask:0xf bank_mask:0xf
    v_dot2_f32_bf16 v41, v141, v13, v41
    s_add_u32 s53, s53, 1024
    v_add_f32_dpp v40, v40, v40 row_ror:4 row_mask:0xf bank_mask:0xf
    v_dot2_f32_bf16 v41, v142, v14, v41
    v_lshlrev_b32 v43, 16, v43
    v_add_f32_dpp v40, v40, v40 row_ror:2 row_mask:0xf bank_mask:0xf
    v_dot2_f32_bf16 v41, v143, v15, v41
    v_max_f32 v28, v28, v43
    v_add_f32_dpp v42, v40, v40 row_ror:1 row_mask:0xf bank_mask:0x4
    s_waitcnt vmcnt(6)
    s_xor_b32 s101, s53, s100
    buffer_load_dwordx4 v[100:103], v1, s[8:11], s101 offen nt
    v_dot2_f32_bf16 v40, v144, v12, 0
    v_add_f32_dpp v41, v41, v41 row_ror:8 row_mask:0xf bank_mask:0xf
    v_dot2_f32_bf16 v40, v145, v13, v40
    s_add_u32 s53, s53, 1024
    v_add_f32_dpp v41, v41, v41 row_ror:4 row_mask:0xf bank_mask:0xf
    v_dot2_f32_bf16 v40, v146, v14, v40
    ds_write_b32 v52, v43 offset:12292
    v_add_f32_dpp v41, v41, v41 row_ror:2 row_mask:0xf bank_mask:0xf
    v_dot2_f32_bf16 v40, v147, v15, v40
    s_nop 0
    v_add_f32_dpp v42, v41, v41 row_ror:1 row_mask:0xf bank_mask:0x8
    buffer_load_dwordx4 a[120:123], v3, s[20:23], s56 offen offset:2048 nt
    s_waitcnt vmcnt(7)
    s_xor_b32 s101, s53, s100
    buffer_load_dwordx4 v[104:107], v1, s[8:11], s101 offen nt
    v_dot2_f32_bf16 v41, v148, v12, 0
    v_add_f32_dpp v40, v40, v40 row_ror:8 row_mask:0xf bank_mask:0xf
    v_dot2_f32_bf16 v41, v149, v13, v41
    s_add_u32 s53, s53, 1024
    v_add_f32_dpp v40, v40, v40 row_ror:4 row_mask:0xf bank_mask:0xf
    v_dot2_f32_bf16 v41, v150, v14, v41
    v_cvt_pk_bf16_f32 v42, v42, v42
    v_add_f32_dpp v40, v40, v40 row_ror:2 row_mask:0xf bank_mask:0xf
    v_dot2_f32_bf16 v41, v151, v15, v41
    v_lshlrev_b32 v42, 16, v42
    v_add_f32_dpp v43, v40, v40 row_ror:1 row_mask:0xf bank_mask:0x1
    s_waitcnt vmcnt(6)
    s_xor_b32 s101, s53, s100
    buffer_load_dwordx4 v[108:111], v1, s[8:11], s101 offen nt
    v_dot2_f32_bf16 v40, v152, v12, 0
    v_add_f32_dpp v41, v41, v41 row_ror:8 row_mask:0xf bank_mask:0xf
    v_dot2_f32_bf16 v40, v153, v13, v40
    s_add_u32 s53, s53, 13312
    v_add_f32_dpp v41, v41, v41 row_ror:4 row_mask:0xf bank_mask:0xf
    v_dot2_f32_bf16 v40, v154, v14, v40
    v_mul_f32 v42, 0x3db504f3, v42
    v_add_f32_dpp v41, v41, v41 row_ror:2 row_mask:0xf bank_mask:0xf
    v_dot2_f32_bf16 v40, v155, v15, v40
    v_cvt_pk_bf16_f32 v42, v42, v42
    v_add_f32_dpp v43, v41, v41 row_ror:1 row_mask:0xf bank_mask:0x2
    buffer_load_dwordx4 a[124:127], v3, s[20:23], s56 offen offset:3072 nt
    s_waitcnt vmcnt(7)
    s_xor_b32 s101, s53, s100
    buffer_load_dwordx4 v[112:115], v1, s[8:11], s101 offen nt
    v_dot2_f32_bf16 v41, v156, v12, 0
    v_add_f32_dpp v40, v40, v40 row_ror:8 row_mask:0xf bank_mask:0xf
    v_dot2_f32_bf16 v41, v157, v13, v41
    s_add_u32 s53, s53, 1024
    v_add_f32_dpp v40, v40, v40 row_ror:4 row_mask:0xf bank_mask:0xf
    v_dot2_f32_bf16 v41, v158, v14, v41
    v_lshlrev_b32 v42, 16, v42
    v_add_f32_dpp v40, v40, v40 row_ror:2 row_mask:0xf bank_mask:0xf
    v_dot2_f32_bf16 v41, v159, v15, v41
    v_max_f32 v28, v28, v42
    v_add_f32_dpp v43, v40, v40 row_ror:1 row_mask:0xf bank_mask:0x4
    s_mov_b32 s54, 10
L_loop1:
    v_cmp_eq_u32 vcc, s73, v70
    s_add_u32 s73, s73, 1
    s_add_u32 s72, s72, 128
    s_and_b32 s58, s54, 3
    s_cmp_eq_u32 s58, s3
    s_cselect_b32 s58, s89, 0x7ff00000
    v_mov_b32 v73, s58
    v_mov_b32 v71, s73
    s_mov_b32 exec_hi, 0
    buffer_load_dword v70, v69, s[44:47], s72 offen
    s_mov_b32 exec_lo, 1
    buffer_store_dword v71, v73, s[44:47], s72 offen
    s_mov_b64 exec, -1
    s_bcnt1_i32_b32 s58, vcc_lo
    s_cmp_ge_u32 s58, 20
    s_cbranch_scc1 L_loop1_up
    s_cmp_lg_u32 s88, 0
    s_cbranch_scc1 L_loop1_down
    s_waitcnt vmcnt(6)
    s_xor_b32 s101, s53, s100
    buffer_load_dwordx4 v[116:119], v1, s[8:11], s101 offen nt
    v_dot2_f32_bf16 v40, v96, v12, 0
    v_add_f32_dpp v41, v41, v41 row_ror:8 row_mask:0xf bank_mask:0xf
    v_dot2_f32_bf16 v40, v97, v13, v40
    s_add_u32 s53, s53, 1024
    v_add_f32_dpp v41, v41, v41 row_ror:4 row_mask:0xf bank_mask:0xf
    v_dot2_f32_bf16 v40, v98, v14, v40
    ds_write_b32 v52, v42 offset:12296
    v_add_f32_dpp v41, v41, v41 row_ror:2 row_mask:0xf bank_mask:0xf
    v_dot2_f32_bf16 v40, v99, v15, v40
    s_nop 0
    v_add_f32_dpp v43, v41, v41 row_ror:1 row_mask:0xf bank_mask:0x8
L_loop1_lo1:
    s_waitcnt vmcnt(6)
    s_xor_b32 s101, s53, s100
    buffer_load_dwordx4 v[120:123], v1, s[8:11], s101 offen nt
    v_dot2_f32_bf16 v41, v100, v12, 0
    v_add_f32_dpp v40, v40, v40 row_ror:8 row_mask:0xf bank_mask:0xf
    v_dot2_f32_bf16 v41, v101, v13, v41
    s_add_u32 s53, s53, 1024
    v_add_f32_dpp v40, v40, v40 row_ror:4 row_mask:0xf bank_mask:0xf
    v_dot2_f32_bf16 v41, v102, v14, v41
    v_cvt_pk_bf16_f32 v43, v43, v43
    v_add_f32_dpp v40, v40, v40 row_ror:2 row_mask:0xf bank_mask:0xf
    v_dot2_f32_bf16 v41, v103, v15, v41
    v_lshlrev_b32 v43, 16, v43
    v_add_f32_dpp v42, v40, v40 row_ror:1 row_mask:0xf bank_mask:0x1
    s_waitcnt vmcnt(6)
    s_xor_b32 s101, s53, s100
    buffer_load_dwordx4 v[124:127], v1, s[8:11], s101 offen nt
    v_dot2_f32_bf16 v40, v104, v12, 0
    v_add_f32_dpp v41, v41, v41 row_ror:8 row_mask:0xf bank_mask:0xf
    v_dot2_f32_bf16 v40, v105, v13, v40
    s_add_u32 s53, s53, 13312
    v_add_f32_dpp v41, v41, v41 row_ror:4 row_mask:0xf bank_mask:0xf
    v_dot2_f32_bf16 v40, v106, v14, v40
    v_mul_f32 v43, 0x3db504f3, v43
    v_add_f32_dpp v41, v41, v41 row_ror:2 row_mask:0xf bank_mask:0xf
    v_dot2_f32_bf16 v40, v107, v15, v40
    v_cvt_pk_bf16_f32 v43, v43, v43
    v_add_f32_dpp v42, v41, v41 row_ror:1 row_mask:0xf bank_mask:0x2
    s_waitcnt vmcnt(6)
    s_xor_b32 s101, s53, s100
    buffer_load_dwordx4 v[128:131], v1, s[8:11], s101 offen nt
    v_dot2_f32_bf16 v41, v108, v12, 0
    v_add_f32_dpp v40, v40, v40 row_ror:8 row_mask:0xf bank_mask:0xf
    v_dot2_f32_bf16 v41, v109, v13, v41
    s_add_u32 s53, s53, 1024
    v_add_f32_dpp v40, v40, v40 row_ror:4 row_mask:0xf bank_mask:0xf
    v_dot2_f32_bf16 v41, v110, v14, v41
    v_lshlrev_b32 v43, 16, v43
    v_add_f32_dpp v40, v40, v40 row_ror:2 row_mask:0xf bank_mask:0xf
    v_dot2_f32_bf16 v41, v111, v15, v41
    v_max_f32 v28, v28, v43
    v_add_f32_dpp v42, v40, v40 row_ror:1 row_mask:0xf bank_mask:0x4
    s_waitcnt vmcnt(6)
    s_xor_b32 s101, s53, s100
    buffer_load_dwordx4 v[132:135], v1, s[8:11], s101 offen nt
    v_dot2_f32_bf16 v40, v112, v12, 0
    v_add_f32_dpp v41, v41, v41 row_ror:8 row_mask:0xf bank_mask:0xf
    v_dot2_f32_bf16 v40, v113, v13, v40
    s_add_u32 s53, s53, 1024
    v_add_f32_dpp v41, v41, v41 row_ror:4 row_mask:0xf bank_mask:0xf
    v_dot2_f32_bf16 v40, v114, v14, v40
    ds_write_b32 v52, v43 offset:12300
    v_add_f32_dpp v41, v41, v41 row_ror:2 row_mask:0xf bank_mask:0xf
    v_dot2_f32_bf16 v40, v115, v15, v40
    v_add_u32 v52, 0x400, v52
    v_add_f32_dpp v42, v41, v41 row_ror:1 row_mask:0xf bank_mask:0x8
    s_waitcnt vmcnt(4)
    s_xor_b32 s101, s53, s100
    buffer_load_dwordx4 v[136:139], v1, s[8:11], s101 offen nt
    v_dot2_f32_bf16 v41, v116, v12, 0
    v_add_f32_dpp v40, v40, v40 row_ror:8 row_mask:0xf bank_mask:0xf
    v_dot2_f32_bf16 v41, v117, v13, v41
    s_add_u32 s53, s53, 1024
    v_add_f32_dpp v40, v40, v40 row_ror:4 row_mask:0xf bank_mask:0xf
    v_dot2_f32_bf16 v41, v118, v14, v41
    v_cvt_pk_bf16_f32 v42, v42, v42
    v_add_f32_dpp v40, v40, v40 row_ror:2 row_mask:0xf bank_mask:0xf
    v_dot2_f32_bf16 v41, v119, v15, v41
    v_lshlrev_b32 v42, 16, v42
    v_add_f32_dpp v43, v40, v40 row_ror:1 row_mask:0xf bank_mask:0x1
    s_waitcnt vmcnt(4)
    s_xor_b32 s101, s53, s100
    buffer_load_dwordx4 v[140:143], v1, s[8:11], s101 offen nt
    v_dot2_f32_bf16 v40, v120, v12, 0
    v_add_f32_dpp v41, v41, v41 row_ror:8 row_mask:0xf bank_mask:0xf
    v_dot2_f32_bf16 v40, v121, v13, v40
    s_add_u32 s53, s53, 13312
    v_add_f32_dpp v41, v41, v41 row_ror:4 row_mask:0xf bank_mask:0xf
    v_dot2_f32_bf16 v40, v122, v14, v40
    v_mul_f32 v42, 0x3db504f3, v42
    v_add_f32_dpp v41, v41, v41 row_ror:2 row_mask:0xf bank_mask:0xf
    v_dot2_f32_bf16 v40, v123, v15, v40
    v_cvt_pk_bf16_f32 v42, v42, v42
    v_add_f32_dpp v43, v41, v41 row_ror:1 row_mask:0xf bank_mask:0x2
    s_waitcnt vmcnt(4)
    s_xor_b32 s101, s53, s100
    buffer_load_dwordx4 v[144:147], v1, s[8:11], s101 offen nt
    v_dot2_f32_bf16 v41, v124, v12, 0
    v_add_f32_dpp v40, v40, v40 row_ror:8 row_mask:0xf bank_mask:0xf
    v_dot2_f32_bf16 v41, v125, v13, v41
    s_add_u32 s53, s53, 1024
    v_add_f32_dpp v40, v40, v40 row_ror:4 row_mask:0xf bank_mask:0xf
    v_dot2_f32_bf16 v41, v126, v14, v41
    v_lshlrev_b32 v42, 16, v42
    v_add_f32_dpp v40, v40, v40 row_ror:2 row_mask:0xf bank_mask:0xf
    v_dot2_f32_bf16 v41, v127, v15, v41
    v_max_f32 v28, v28, v42
    v_add_f32_dpp v43, v40, v40 row_ror:1 row_mask:0xf bank_mask:0x4
    s_waitcnt vmcnt(4)
    s_xor_b32 s101, s53, s100
    buffer_load_dwordx4 v[148:151], v1, s[8:11], s101 offen nt
    v_dot2_f32_bf16 v40, v128, v12, 0
    v_add_f32_dpp v41, v41, v41 row_ror:8 row_mask:0xf bank_mask:0xf
    v_dot2_f32_bf16 v40, v129, v13, v40
    s_add_u32 s53, s53, 1024
    v_add_f32_dpp v41, v41, v41 row_ror:4 row_mask:0xf bank_mask:0xf
    v_dot2_f32_bf16 v40, v130, v14, v40
    ds_write_b32 v52, v42 offset:12288
    v_add_f32_dpp v41, v41, v41 row_ror:2 row_mask:0xf bank_mask:0xf
    v_dot2_f32_bf16 v40, v131, v15, v40
    s_nop 0
    v_add_f32_dpp v43, v41, v41 row_ror:1 row_mask:0xf bank_mask:0x8
    s_waitcnt vmcnt(4)
    s_xor_b32 s101, s53, s100
    buffer_load_dwordx4 v[152:155], v1, s[8:11], s101 offen nt
    v_dot2_f32_bf16 v41, v132, v12, 0
    v_add_f32_dpp v40, v40, v40 row_ror:8 row_mask:0xf bank_mask:0xf
    v_dot2_f32_bf16 v41, v133, v13, v41
    s_add_u32 s53, s53, 1024
    v_add_f32_dpp v40, v40, v40 row_ror:4 row_mask:0xf bank_mask:0xf
    v_dot2_f32_bf16 v41, v134, v14, v41
    v_cvt_pk_bf16_f32 v43, v43, v43
    v_add_f32_dpp v40, v40, v40 row_ror:2 row_mask:0xf bank_mask:0xf
    v_dot2_f32_bf16 v41, v135, v15, v41
    v_lshlrev_b32 v43, 16, v43
    v_add_f32_dpp v42, v40, v40 row_ror:1 row_mask:0xf bank_mask:0x1
    s_waitcnt vmcnt(4)
    s_xor_b32 s101, s53, s100
    buffer_load_dwordx4 v[156:159], v1, s[8:11], s101 offen nt
    v_dot2_f32_bf16 v40, v136, v12, 0
    v_add_f32_dpp v41, v41, v41 row_ror:8 row_mask:0xf bank_mask:0xf
    v_dot2_f32_bf16 v40, v137, v13, v40
    s_add_u32 s53, s53, 13312
    v_add_f32_dpp v41, v41, v41 row_ror:4 row_mask:0xf bank_mask:0xf
    v_dot2_f32_bf16 v40, v138, v14, v40
    v_mul_f32 v43, 0x3db504f3, v43
    v_add_f32_dpp v41, v41, v41 row_ror:2 row_mask:0xf bank_mask:0xf
    v_dot2_f32_bf16 v40, v139, v15, v40
    v_cvt_pk_bf16_f32 v43, v43, v43
    v_add_f32_dpp v42, v41, v41 row_ror:1 row_mask:0xf bank_mask:0x2
    s_waitcnt vmcnt(4)
    s_cmp_eq_u32 s54, 1
    s_cselect_b64 s[8:9], s[12:13], s[8:9]
    s_cselect_b32 s53, s71, s53
    s_xor_b32 s101, s53, s100
    buffer_load_dwordx4 v[96:99], v1, s[8:11], s101 offen nt
    v_dot2_f32_bf16 v41, v140, v12, 0
    v_add_f32_dpp v40, v40, v40 row_ror:8 row_mask:0xf bank_mask:0xf
    v_dot2_f32_bf16 v41, v141, v13, v41
    s_add_u32 s53, s53, 1024
    v_add_f32_dpp v40, v40, v40 row_ror:4 row_mask:0xf bank_mask:0xf
    v_dot2_f32_bf16 v41, v142, v14, v41
    v_lshlrev_b32 v43, 16, v43
    v_add_f32_dpp v40, v40, v40 row_ror:2 row_mask:0xf bank_mask:0xf
    v_dot2_f32_bf16 v41, v143, v15, v41
    v_max_f32 v28, v28, v43
    v_add_f32_dpp v42, v40, v40 row_ror:1 row_mask:0xf bank_mask:0x4
    s_waitcnt vmcnt(4)
    s_xor_b32 s101, s53, s100
    buffer_load_dwordx4 v[100:103], v1, s[8:11], s101 offen nt
    v_dot2_f32_bf16 v40, v144, v12, 0
    v_add_f32_dpp v41, v41, v41 row_ror:8 row_mask:0xf bank_mask:0xf
    v_dot2_f32_bf16 v40, v145, v13, v40
    s_add_u32 s53, s53, 1024
    v_add_f32_dpp v41, v41, v41 row_ror:4 row_mask:0xf bank_mask:0xf
    v_dot2_f32_bf16 v40, v146, v14, v40
    ds_write_b32 v52, v43 offset:12292
    v_add_f32_dpp v41, v41, v41 row_ror:2 row_mask:0xf bank_mask:0xf
    v_dot2_f32_bf16 v40, v147, v15, v40
    s_nop 0
    v_add_f32_dpp v42, v41, v41 row_ror:1 row_mask:0xf bank_mask:0x8
    s_waitcnt vmcnt(4)
    s_xor_b32 s101, s53, s100
    buffer_load_dwordx4 v[104:107], v1, s[8:11], s101 offen nt
    v_dot2_f32_bf16 v41, v148, v12, 0
    v_add_f32_dpp v40, v40, v40 row_ror:8 row_mask:0xf bank_mask:0xf
    v_dot2_f32_bf16 v41, v149, v13, v41
    s_add_u32 s53, s53, 1024
    v_add_f32_dpp v40, v40, v40 row_ror:4 row_mask:0xf bank_mask:0xf
    v_dot2_f32_bf16 v41, v150, v14, v41
    v_cvt_pk_bf16_f32 v42, v42, v42
    v_add_f32_dpp v40, v40, v40 row_ror:2 row_mask:0xf bank_mask:0xf
    v_dot2_f32_bf16 v41, v151, v15, v41
    v_lshlrev_b32 v42, 16, v42
    v_add_f32_dpp v43, v40, v40 row_ror:1 row_mask:0xf bank_mask:0x1
    s_waitcnt vmcnt(4)
    s_xor_b32 s101, s53, s100
    buffer_load_dwordx4 v[108:111], v1, s[8:11], s101 offen nt
    v_dot2_f32_bf16 v40, v152, v12, 0
    v_add_f32_dpp v41, v41, v41 row_ror:8 row_mask:0xf bank_mask:0xf
    v_dot2_f32_bf16 v40, v153, v13, v40
    s_add_u32 s53, s53, 13312
    v_add_f32_dpp v41, v41, v41 row_ror:4 row_mask:0xf bank_mask:0xf
    v_dot2_f32_bf16 v40, v154, v14, v40
    v_mul_f32 v42, 0x3db504f3, v42
    v_add_f32_dpp v41, v41, v41 row_ror:2 row_mask:0xf bank_mask:0xf
    v_dot2_f32_bf16 v40, v155, v15, v40
    v_cvt_pk_bf16_f32 v42, v42, v42
    v_add_f32_dpp v43, v41, v41 row_ror:1 row_mask:0xf bank_mask:0x2
    s_waitcnt vmcnt(4)
    s_xor_b32 s101, s53, s100
    buffer_load_dwordx4 v[112:115], v1, s[8:11], s101 offen nt
    v_dot2_f32_bf16 v41, v156, v12, 0
    v_add_f32_dpp v40, v40, v40 row_ror:8 row_mask:0xf bank_mask:0xf
    v_dot2_f32_bf16 v41, v157, v13, v41
    s_add_u32 s53, s53, 1024
    v_add_f32_dpp v40, v40, v40 row_ror:4 row_mask:0xf bank_mask:0xf
    v_dot2_f32_bf16 v41, v158, v14, v41
    v_lshlrev_b32 v42, 16, v42
    v_add_f32_dpp v40, v40, v40 row_ror:2 row_mask:0xf bank_mask:0xf
    v_dot2_f32_bf16 v41, v159, v15, v41
    v_max_f32 v28, v28, v42
    v_add_f32_dpp v43, v40, v40 row_ror:1 row_mask:0xf bank_mask:0x4
    s_sub_u32 s54, s54, 1
    s_cmp_lg_u32 s54, 0
    s_cbranch_scc1 L_loop1
    s_branch L_loop1_end
L_loop1_down:
    s_mov_b32 s88, 0
    s_waitcnt vmcnt(7)
    v_dot2_f32_bf16 v40, v96, v12, 0
    v_add_f32_dpp v41, v41, v41 row_ror:8 row_mask:0xf bank_mask:0xf
    v_dot2_f32_bf16 v40, v97, v13, v40
    ds_write_b32 v52, v42 offset:12296
    v_add_f32_dpp v41, v41, v41 row_ror:4 row_mask:0xf bank_mask:0xf
    v_dot2_f32_bf16 v40, v98, v14, v40
    s_nop 0
    v_add_f32_dpp v41, v41, v41 row_ror:2 row_mask:0xf bank_mask:0xf
    v_dot2_f32_bf16 v40, v99, v15, v40
    s_nop 0
    v_add_f32_dpp v43, v41, v41 row_ror:1 row_mask:0xf bank_mask:0x8
    s_branch L_loop1_lo1
L_loop1_up:
    s_cmp_lg_u32 s88, 0
    s_cbranch_scc1 L_loop1_hi
    s_mov_b32 s88, 1
    s_xor_b32 s101, s53, s100
    buffer_load_dwordx4 v[116:119], v1, s[8:11], s101 offen nt
    s_add_u32 s53, s53, 1024
L_loop1_hi:
    s_waitcnt vmcnt(7)
    s_xor_b32 s101, s53, s100
    buffer_load_dwordx4 v[120:123], v1, s[8:11], s101 offen nt
    v_dot2_f32_bf16 v40, v96, v12, 0
    v_add_f32_dpp v41, v41, v41 row_ror:8 row_mask:0xf bank_mask:0xf
    v_dot2_f32_bf16 v40, v97, v13, v40
    s_add_u32 s53, s53, 1024
    v_add_f32_dpp v41, v41, v41 row_ror:4 row_mask:0xf bank_mask:0xf
    v_dot2_f32_bf16 v40, v98, v14, v40
    ds_write_b32 v52, v42 offset:12296
    v_add_f32_dpp v41, v41, v41 row_ror:2 row_mask:0xf bank_mask:0xf
    v_dot2_f32_bf16 v40, v99, v15, v40
    s_nop 0
    v_add_f32_dpp v43, v41, v41 row_ror:1 row_mask:0xf bank_mask:0x8
    s_waitcnt vmcnt(7)
    s_xor_b32 s101, s53, s100
    buffer_load_dwordx4 v[124:127], v1, s[8:11], s101 offen nt
    v_dot2_f32_bf16 v41, v100, v12, 0
    v_add_f32_dpp v40, v40, v40 row_ror:8 row_mask:0xf bank_mask:0xf
    v_dot2_f32_bf16 v41, v101, v13, v41
    s_add_u32 s53, s53, 13312
    v_add_f32_dpp v40, v40, v40 row_ror:4 row_mask:0xf bank_mask:0xf
    v_dot2_f32_bf16 v41, v102, v14, v41
    v_cvt_pk_bf16_f32 v43, v43, v43
    v_add_f32_dpp v40, v40, v40 row_ror:2 row_mask:0xf bank_mask:0xf
    v_dot2_f32_bf16 v41, v103, v15, v41
    v_lshlrev_b32 v43, 16, v43
    v_add_f32_dpp v42, v40, v40 row_ror:1 row_mask:0xf bank_mask:0x1
    s_waitcnt vmcnt(7)
    s_xor_b32 s101, s53, s100
    buffer_load_dwordx4 v[128:131], v1, s[8:11], s101 offen nt
    v_dot2_f32_bf16 v40, v104, v12, 0
    v_add_f32_dpp v41, v41, v41 row_ror:8 row_mask:0xf bank_mask:0xf
    v_dot2_f32_bf16 v40, v105, v13, v40
    s_add_u32 s53, s53, 1024
    v_add_f32_dpp v41, v41, v41 row_ror:4 row_mask:0xf bank_mask:0xf
    v_dot2_f32_bf16 v40, v106, v14, v40
    v_mul_f32 v43, 0x3db504f3, v43
    v_add_f32_dpp v41, v41, v41 row_ror:2 row_mask:0xf bank_mask:0xf
    v_dot2_f32_bf16 v40, v107, v15, v40
    v_cvt_pk_bf16_f32 v43, v43, v43
    v_add_f32_dpp v42, v41, v41 row_ror:1 row_mask:0xf bank_mask:0x2
    s_waitcnt vmcnt(7)
    s_xor_b32 s101, s53, s100
    buffer_load_dwordx4 v[132:135], v1, s[8:11], s101 offen nt
    v_dot2_f32_bf16 v41, v108, v12, 0
    v_add_f32_dpp v40, v40, v40 row_ror:8 row_mask:0xf bank_mask:0xf
    v_dot2_f32_bf16 v41, v109, v13, v41
    s_add_u32 s53, s53, 1024
    v_add_f32_dpp v40, v40, v40 row_ror:4 row_mask:0xf bank_mask:0xf
    v_dot2_f32_bf16 v41, v110, v14, v41
    v_lshlrev_b32 v43, 16, v43
    v_add_f32_dpp v40, v40, v40 row_ror:2 row_mask:0xf bank_mask:0xf
    v_dot2_f32_bf16 v41, v111, v15, v41
    v_max_f32 v28, v28, v43
    v_add_f32_dpp v42, v40, v40 row_ror:1 row_mask:0xf bank_mask:0x4
    s_waitcnt vmcnt(7)
    s_xor_b32 s101, s53, s100
    buffer_load_dwordx4 v[136:139], v1, s[8:11], s101 offen nt
    v_dot2_f32_bf16 v40, v112, v12, 0
    v_add_f32_dpp v41, v41, v41 row_ror:8 row_mask:0xf bank_mask:0xf
    v_dot2_f32_bf16 v40, v113, v13, v40
    s_add_u32 s53, s53, 1024
    v_add_f32_dpp v41, v41, v41 row_ror:4 row_mask:0xf bank_mask:0xf
    v_dot2_f32_bf16 v40, v114, v14, v40
    ds_write_b32 v52, v43 offset:12300
    v_add_f32_dpp v41, v41, v41 row_ror:2 row_mask:0xf bank_mask:0xf
    v_dot2_f32_bf16 v40, v115, v15, v40
    v_add_u32 v52, 0x400, v52
    v_add_f32_dpp v42, v41, v41 row_ror:1 row_mask:0xf bank_mask:0x8
    s_waitcnt vmcnt(5)
    s_xor_b32 s101, s53, s100
    buffer_load_dwordx4 v[140:143], v1, s[8:11], s101 offen nt
    v_dot2_f32_bf16 v41, v116, v12, 0
    v_add_f32_dpp v40, v40, v40 row_ror:8 row_mask:0xf bank_mask:0xf
    v_dot2_f32_bf16 v41, v117, v13, v41
    s_add_u32 s53, s53, 13312
    v_add_f32_dpp v40, v40, v40 row_ror:4 row_mask:0xf bank_mask:0xf
    v_dot2_f32_bf16 v41, v118, v14, v41
    v_cvt_pk_bf16_f32 v42, v42, v42
    v_add_f32_dpp v40, v40, v40 row_ror:2 row_mask:0xf bank_mask:0xf
    v_dot2_f32_bf16 v41, v119, v15, v41
    v_lshlrev_b32 v42, 16, v42
    v_add_f32_dpp v43, v40, v40 row_ror:1 row_mask:0xf bank_mask:0x1
    s_waitcnt vmcnt(5)
    s_xor_b32 s101, s53, s100
    buffer_load_dwordx4 v[144:147], v1, s[8:11], s101 offen nt
    v_dot2_f32_bf16 v40, v120, v12, 0
    v_add_f32_dpp v41, v41, v41 row_ror:8 row_mask:0xf bank_mask:0xf
    v_dot2_f32_bf16 v40, v121, v13, v40
    s_add_u32 s53, s53, 1024
    v_add_f32_dpp v41, v41, v41 row_ror:4 row_mask:0xf bank_mask:0xf
    v_dot2_f32_bf16 v40, v122, v14, v40
    v_mul_f32 v42, 0x3db504f3, v42
    v_add_f32_dpp v41, v41, v41 row_ror:2 row_mask:0xf bank_mask:0xf
    v_dot2_f32_bf16 v40, v123, v15, v40
    v_cvt_pk_bf16_f32 v42, v42, v42
    v_add_f32_dpp v43, v41, v41 row_ror:1 row_mask:0xf bank_mask:0x2
    s_waitcnt vmcnt(5)
    s_xor_b32 s101, s53, s100
    buffer_load_dwordx4 v[148:151], v1, s[8:11], s101 offen nt
    v_dot2_f32_bf16 v41, v124, v12, 0
    v_add_f32_dpp v40, v40, v40 row_ror:8 row_mask:0xf bank_mask:0xf
    v_dot2_f32_bf16 v41, v125, v13, v41
    s_add_u32 s53, s53, 1024
    v_add_f32_dpp v40, v40, v40 row_ror:4 row_mask:0xf bank_mask:0xf
    v_dot2_f32_bf16 v41, v126, v14, v41
    v_lshlrev_b32 v42, 16, v42
    v_add_f32_dpp v40, v40, v40 row_ror:2 row_mask:0xf bank_mask:0xf
    v_dot2_f32_bf16 v41, v127, v15, v41
    v_max_f32 v28, v28, v42
    v_add_f32_dpp v43, v40, v40 row_ror:1 row_mask:0xf bank_mask:0x4
    s_waitcnt vmcnt(5)
    s_xor_b32 s101, s53, s100
    buffer_load_dwordx4 v[152:155], v1, s[8:11], s101 offen nt
    v_dot2_f32_bf16 v40, v128, v12, 0
    v_add_f32_dpp v41, v41, v41 row_ror:8 row_mask:0xf bank_mask:0xf
    v_dot2_f32_bf16 v40, v129, v13, v40
    s_add_u32 s53, s53, 1024
    v_add_f32_dpp v41, v41, v41 row_ror:4 row_mask:0xf bank_mask:0xf
    v_dot2_f32_bf16 v40, v130, v14, v40
    ds_write_b32 v52, v42 offset:12288
    v_add_f32_dpp v41, v41, v41 row_ror:2 row_mask:0xf bank_mask:0xf
    v_dot2_f32_bf16 v40, v131, v15, v40
    s_nop 0
    v_add_f32_dpp v43, v41, v41 row_ror:1 row_mask:0xf bank_mask:0x8
    s_waitcnt vmcnt(5)
    s_xor_b32 s101, s53, s100
    buffer_load_dwordx4 v[156:159], v1, s[8:11], s101 offen nt
    v_dot2_f32_bf16 v41, v132, v12, 0
    v_add_f32_dpp v40, v40, v40 row_ror:8 row_mask:0xf bank_mask:0xf
    v_dot2_f32_bf16 v41, v133, v13, v41
    s_add_u32 s53, s53, 13312
    v_add_f32_dpp v40, v40, v40 row_ror:4 row_mask:0xf bank_mask:0xf
    v_dot2_f32_bf16 v41, v134, v14, v41
    v_cvt_pk_bf16_f32 v43, v43, v43
    v_add_f32_dpp v40, v40, v40 row_ror:2 row_mask:0xf bank_mask:0xf
    v_dot2_f32_bf16 v41, v135, v15, v41
    v_lshlrev_b32 v43, 16, v43
    v_add_f32_dpp v42, v40, v40 row_ror:1 row_mask:0xf bank_mask:0x1
    s_waitcnt vmcnt(5)
    s_cmp_eq_u32 s54, 1
    s_cselect_b64 s[8:9], s[12:13], s[8:9]
    s_cselect_b32 s53, s71, s53
    s_xor_b32 s101, s53, s100
    buffer_load_dwordx4 v[96:99], v1, s[8:11], s101 offen nt
    v_dot2_f32_bf16 v40, v136, v12, 0
    v_add_f32_dpp v41, v41, v41 row_ror:8 row_mask:0xf bank_mask:0xf
    v_dot2_f32_bf16 v40, v137, v13, v40
    s_add_u32 s53, s53, 1024
    v_add_f32_dpp v41, v41, v41 row_ror:4 row_mask:0xf bank_mask:0xf
    v_dot2_f32_bf16 v40, v138, v14, v40
    v_mul_f32 v43, 0x3db504f3, v43
    v_add_f32_dpp v41, v41, v41 row_ror:2 row_mask:0xf bank_mask:0xf
    v_dot2_f32_bf16 v40, v139, v15, v40
    v_cvt_pk_bf16_f32 v43, v43, v43
    v_add_f32_dpp v42, v41, v41 row_ror:1 row_mask:0xf bank_mask:0x2
    s_waitcnt vmcnt(5)
    s_xor_b32 s101, s53, s100
    buffer_load_dwordx4 v[100:103], v1, s[8:11], s101 offen nt
    v_dot2_f32_bf16 v41, v140, v12, 0
    v_add_f32_dpp v40, v40, v40 row_ror:8 row_mask:0xf bank_mask:0xf
    v_dot2_f32_bf16 v41, v141, v13, v41
    s_add_u32 s53, s53, 1024
    v_add_f32_dpp v40, v40, v40 row_ror:4 row_mask:0xf bank_mask:0xf
    v_dot2_f32_bf16 v41, v142, v14, v41
    v_lshlrev_b32 v43, 16, v43
    v_add_f32_dpp v40, v40, v40 row_ror:2 row_mask:0xf bank_mask:0xf
    v_dot2_f32_bf16 v41, v143, v15, v41
    v_max_f32 v28, v28, v43
    v_add_f32_dpp v42, v40, v40 row_ror:1 row_mask:0xf bank_mask:0x4
    s_waitcnt vmcnt(5)
    s_xor_b32 s101, s53, s100
    buffer_load_dwordx4 v[104:107], v1, s[8:11], s101 offen nt
    v_dot2_f32_bf16 v40, v144, v12, 0
    v_add_f32_dpp v41, v41, v41 row_ror:8 row_mask:0xf bank_mask:0xf
    v_dot2_f32_bf16 v40, v145, v13, v40
    s_add_u32 s53, s53, 1024
    v_add_f32_dpp v41, v41, v41 row_ror:4 row_mask:0xf bank_mask:0xf
    v_dot2_f32_bf16 v40, v146, v14, v40
    ds_write_b32 v52, v43 offset:12292
    v_add_f32_dpp v41, v41, v41 row_ror:2 row_mask:0xf bank_mask:0xf
    v_dot2_f32_bf16 v40, v147, v15, v40
    s_nop 0
    v_add_f32_dpp v42, v41, v41 row_ror:1 row_mask:0xf bank_mask:0x8
    s_waitcnt vmcnt(5)
    s_xor_b32 s101, s53, s100
    buffer_load_dwordx4 v[108:111], v1, s[8:11], s101 offen nt
    v_dot2_f32_bf16 v41, v148, v12, 0
    v_add_f32_dpp v40, v40, v40 row_ror:8 row_mask:0xf bank_mask:0xf
    v_dot2_f32_bf16 v41, v149, v13, v41
    s_add_u32 s53, s53, 13312
    v_add_f32_dpp v40, v40, v40 row_ror:4 row_mask:0xf bank_mask:0xf
    v_dot2_f32_bf16 v41, v150, v14, v41
    v_cvt_pk_bf16_f32 v42, v42, v42
    v_add_f32_dpp v40, v40, v40 row_ror:2 row_mask:0xf bank_mask:0xf
    v_dot2_f32_bf16 v41, v151, v15, v41
    v_lshlrev_b32 v42, 16, v42
    v_add_f32_dpp v43, v40, v40 row_ror:1 row_mask:0xf bank_mask:0x1
    s_waitcnt vmcnt(5)
    s_xor_b32 s101, s53, s100
    buffer_load_dwordx4 v[112:115], v1, s[8:11], s101 offen nt
    v_dot2_f32_bf16 v40, v152, v12, 0
    v_add_f32_dpp v41, v41, v41 row_ror:8 row_mask:0xf bank_mask:0xf
    v_dot2_f32_bf16 v40, v153, v13, v40
    s_add_u32 s53, s53, 1024
    v_add_f32_dpp v41, v41, v41 row_ror:4 row_mask:0xf bank_mask:0xf
    v_dot2_f32_bf16 v40, v154, v14, v40
    v_mul_f32 v42, 0x3db504f3, v42
    v_add_f32_dpp v41, v41, v41 row_ror:2 row_mask:0xf bank_mask:0xf
    v_dot2_f32_bf16 v40, v155, v15, v40
    v_cvt_pk_bf16_f32 v42, v42, v42
    v_add_f32_dpp v43, v41, v41 row_ror:1 row_mask:0xf bank_mask:0x2
    s_waitcnt vmcnt(5)
    s_xor_b32 s101, s53, s100
    buffer_load_dwordx4 v[116:119], v1, s[8:11], s101 offen nt
    v_dot2_f32_bf16 v41, v156, v12, 0
    v_add_f32_dpp v40, v40, v40 row_ror:8 row_mask:0xf bank_mask:0xf
    v_dot2_f32_bf16 v41, v157, v13, v41
    s_add_u32 s53, s53, 1024
    v_add_f32_dpp v40, v40, v40 row_ror:4 row_mask:0xf bank_mask:0xf
    v_dot2_f32_bf16 v41, v158, v14, v41
    v_lshlrev_b32 v42, 16, v42
    v_add_f32_dpp v40, v40, v40 row_ror:2 row_mask:0xf bank_mask:0xf
    v_dot2_f32_bf16 v41, v159, v15, v41
    v_max_f32 v28, v28, v42
    v_add_f32_dpp v43, v40, v40 row_ror:1 row_mask:0xf bank_mask:0x4
    s_sub_u32 s54, s54, 1
    s_cmp_lg_u32 s54, 0
    s_cbranch_scc1 L_loop1
L_loop1_end:
    ds_write_b32 v52, v42 offset:12296
    v_add_f32_dpp v41, v41, v41 row_ror:8 row_mask:0xf bank_mask:0xf
    s_nop 1
    v_add_f32_dpp v41, v41, v41 row_ror:4 row_mask:0xf bank_mask:0xf
    s_nop 1
    v_add_f32_dpp v41, v41, v41 row_ror:2 row_mask:0xf bank_mask:0xf
    s_nop 1
    v_add_f32_dpp v43, v41, v41 row_ror:1 row_mask:0xf bank_mask:0x8
    v_cvt_pk_bf16_f32 v43, v43, v43
    v_lshlrev_b32 v43, 16, v43
    v_mul_f32 v43, 0x3db504f3, v43
    v_cvt_pk_bf16_f32 v43, v43, v43
    v_lshlrev_b32 v43, 16, v43
    v_max_f32 v28, v28, v43
    ds_write_b32 v52, v43 offset:12300
    v_add_u32 v52, 0x400, v52
    s_lshl_b32 s58, s3, 14
    v_add_u32 v52, s58, v1
    v_max_f32_dpp v28, v28, v28 row_ror:8 row_mask:0xf bank_mask:0xf
    s_nop 1
    v_max_f32_dpp v28, v28, v28 row_ror:4 row_mask:0xf bank_mask:0xf
    v_mov_b32 v32, v28
    s_nop 1
    v_permlane16_swap_b32 v28, v32
    v_max_f32 v28, v28, v32
    v_mov_b32 v32, v28
    s_nop 1
    v_permlane32_swap_b32 v28, v32
    v_max_f32 v28, v28, v32
    s_lshl_b32 s58, s3, 2
    v_mov_b32 v33, s58
    ds_write_b32 v33, v28 offset:8192
    s_waitcnt lgkmcnt(0)
    s_barrier
    ds_read_b128 v[80:83], v59 offset:8192
    ds_read_b128 v[48:51], v52 offset:12288
    v_add_u32 v52, 0x400, v52
    s_waitcnt lgkmcnt(1)
    v_max3_f32 v28, v80, v81, v82
    v_max_f32 v28, v28, v83
    v_mul_f32 v29, s57, v28
    v_or_b32 v28, v28, v74
    s_waitcnt lgkmcnt(0)
    v_fma_f32 v32, v48, s57, -v29
    v_exp_f32 v44, v32
    s_nop 0
    v_cvt_pk_bf16_f32 v46, v44, v44
    s_nop 1
    s_mov_b32 s54, 15
L_loop2:
    v_cmp_eq_u32 vcc, s73, v70
    s_add_u32 s73, s73, 1
    s_add_u32 s72, s72, 128
    s_and_b32 s58, s54, 3
    s_cmp_eq_u32 s58, s3
    s_cselect_b32 s58, s89, 0x7ff00000
    v_mov_b32 v73, s58
    v_mov_b32 v71, s73
    s_mov_b32 exec_hi, 0
    buffer_load_dword v70, v69, s[44:47], s72 offen
    s_mov_b32 exec_lo, 1
    buffer_store_dword v71, v73, s[44:47], s72 offen
    s_mov_b64 exec, -1
    s_bcnt1_i32_b32 s58, vcc_lo
    s_cmp_ge_u32 s58, 20
    s_cbranch_scc1 L_loop2_up
    s_cmp_lg_u32 s88, 0
    s_cbranch_scc1 L_loop2_down
    v_add_f32 v30, v30, v44
    v_and_b32_dpp v8, v46, v16 row_newbcast:0 row_mask:0xf bank_mask:0xf
    v_and_b32_dpp v9, v46, v17 row_newbcast:0 row_mask:0xf bank_mask:0xf
    v_and_b32_dpp v10, v46, v18 row_newbcast:0 row_mask:0xf bank_mask:0xf
    v_and_b32_dpp v11, v46, v19 row_newbcast:0 row_mask:0xf bank_mask:0xf
    s_waitcnt vmcnt(6)
    s_xor_b32 s101, s53, s100
    buffer_load_dwordx4 v[116:119], v1, s[8:11], s101 offen nt
    s_add_u32 s53, s53, 1024
    v_mfma_f32_16x16x32_bf16 v[4:7], v[8:11], v[96:99], v[4:7]
L_loop2_lo1:
    v_fma_f32 v32, v49, s57, -v29
    v_exp_f32 v45, v32
    v_and_b32_dpp v8, v46, v16 row_newbcast:4 row_mask:0xf bank_mask:0xf
    v_and_b32_dpp v9, v46, v17 row_newbcast:4 row_mask:0xf bank_mask:0xf
    v_and_b32_dpp v10, v46, v18 row_newbcast:4 row_mask:0xf bank_mask:0xf
    v_and_b32_dpp v11, v46, v19 row_newbcast:4 row_mask:0xf bank_mask:0xf
    s_waitcnt vmcnt(6)
    s_xor_b32 s101, s53, s100
    buffer_load_dwordx4 v[120:123], v1, s[8:11], s101 offen nt
    s_add_u32 s53, s53, 1024
    v_mfma_f32_16x16x32_bf16 v[4:7], v[8:11], v[100:103], v[4:7]
    v_cvt_pk_bf16_f32 v47, v45, v45
    v_and_b32_dpp v8, v46, v16 row_newbcast:8 row_mask:0xf bank_mask:0xf
    v_and_b32_dpp v9, v46, v17 row_newbcast:8 row_mask:0xf bank_mask:0xf
    v_and_b32_dpp v10, v46, v18 row_newbcast:8 row_mask:0xf bank_mask:0xf
    v_and_b32_dpp v11, v46, v19 row_newbcast:8 row_mask:0xf bank_mask:0xf
    s_waitcnt vmcnt(6)
    s_xor_b32 s101, s53, s100
    buffer_load_dwordx4 v[124:127], v1, s[8:11], s101 offen nt
    s_add_u32 s53, s53, 13312
    v_mfma_f32_16x16x32_bf16 v[4:7], v[8:11], v[104:107], v[4:7]
    v_and_b32_dpp v8, v46, v16 row_newbcast:12 row_mask:0xf bank_mask:0xf
    v_and_b32_dpp v9, v46, v17 row_newbcast:12 row_mask:0xf bank_mask:0xf
    v_and_b32_dpp v10, v46, v18 row_newbcast:12 row_mask:0xf bank_mask:0xf
    v_and_b32_dpp v11, v46, v19 row_newbcast:12 row_mask:0xf bank_mask:0xf
    s_waitcnt vmcnt(6)
    s_xor_b32 s101, s53, s100
    buffer_load_dwordx4 v[128:131], v1, s[8:11], s101 offen nt
    s_add_u32 s53, s53, 1024
    v_mfma_f32_16x16x32_bf16 v[4:7], v[8:11], v[108:111], v[4:7]
    v_add_f32 v30, v30, v45
    v_and_b32_dpp v8, v47, v16 row_newbcast:0 row_mask:0xf bank_mask:0xf
    v_and_b32_dpp v9, v47, v17 row_newbcast:0 row_mask:0xf bank_mask:0xf
    v_and_b32_dpp v10, v47, v18 row_newbcast:0 row_mask:0xf bank_mask:0xf
    v_and_b32_dpp v11, v47, v19 row_newbcast:0 row_mask:0xf bank_mask:0xf
    s_waitcnt vmcnt(6)
    s_xor_b32 s101, s53, s100
    buffer_load_dwordx4 v[132:135], v1, s[8:11], s101 offen nt
    s_add_u32 s53, s53, 1024
    v_mfma_f32_16x16x32_bf16 v[4:7], v[8:11], v[112:115], v[4:7]
    v_fma_f32 v32, v50, s57, -v29
    v_exp_f32 v44, v32
    v_and_b32_dpp v8, v47, v16 row_newbcast:4 row_mask:0xf bank_mask:0xf
    v_and_b32_dpp v9, v47, v17 row_newbcast:4 row_mask:0xf bank_mask:0xf
    v_and_b32_dpp v10, v47, v18 row_newbcast:4 row_mask:0xf bank_mask:0xf
    v_and_b32_dpp v11, v47, v19 row_newbcast:4 row_mask:0xf bank_mask:0xf
    s_waitcnt vmcnt(4)
    s_xor_b32 s101, s53, s100
    buffer_load_dwordx4 v[136:139], v1, s[8:11], s101 offen nt
    s_add_u32 s53, s53, 1024
    v_mfma_f32_16x16x32_bf16 v[4:7], v[8:11], v[116:119], v[4:7]
    v_cvt_pk_bf16_f32 v46, v44, v44
    v_and_b32_dpp v8, v47, v16 row_newbcast:8 row_mask:0xf bank_mask:0xf
    v_and_b32_dpp v9, v47, v17 row_newbcast:8 row_mask:0xf bank_mask:0xf
    v_and_b32_dpp v10, v47, v18 row_newbcast:8 row_mask:0xf bank_mask:0xf
    v_and_b32_dpp v11, v47, v19 row_newbcast:8 row_mask:0xf bank_mask:0xf
    s_waitcnt vmcnt(4)
    s_xor_b32 s101, s53, s100
    buffer_load_dwordx4 v[140:143], v1, s[8:11], s101 offen nt
    s_add_u32 s53, s53, 13312
    v_mfma_f32_16x16x32_bf16 v[4:7], v[8:11], v[120:123], v[4:7]
    v_and_b32_dpp v8, v47, v16 row_newbcast:12 row_mask:0xf bank_mask:0xf
    v_and_b32_dpp v9, v47, v17 row_newbcast:12 row_mask:0xf bank_mask:0xf
    v_and_b32_dpp v10, v47, v18 row_newbcast:12 row_mask:0xf bank_mask:0xf
    v_and_b32_dpp v11, v47, v19 row_newbcast:12 row_mask:0xf bank_mask:0xf
    s_waitcnt vmcnt(4)
    s_xor_b32 s101, s53, s100
    buffer_load_dwordx4 v[144:147], v1, s[8:11], s101 offen nt
    s_add_u32 s53, s53, 1024
    v_mfma_f32_16x16x32_bf16 v[4:7], v[8:11], v[124:127], v[4:7]
    v_add_f32 v30, v30, v44
    v_and_b32_dpp v8, v46, v16 row_newbcast:0 row_mask:0xf bank_mask:0xf
    v_and_b32_dpp v9, v46, v17 row_newbcast:0 row_mask:0xf bank_mask:0xf
    v_and_b32_dpp v10, v46, v18 row_newbcast:0 row_mask:0xf bank_mask:0xf
    v_and_b32_dpp v11, v46, v19 row_newbcast:0 row_mask:0xf bank_mask:0xf
    s_waitcnt vmcnt(4)
    s_xor_b32 s101, s53, s100
    buffer_load_dwordx4 v[148:151], v1, s[8:11], s101 offen nt
    s_add_u32 s53, s53, 1024
    v_mfma_f32_16x16x32_bf16 v[4:7], v[8:11], v[128:131], v[4:7]
    v_fma_f32 v32, v51, s57, -v29
    v_exp_f32 v45, v32
    v_and_b32_dpp v8, v46, v16 row_newbcast:4 row_mask:0xf bank_mask:0xf
    v_and_b32_dpp v9, v46, v17 row_newbcast:4 row_mask:0xf bank_mask:0xf
    v_and_b32_dpp v10, v46, v18 row_newbcast:4 row_mask:0xf bank_mask:0xf
    v_and_b32_dpp v11, v46, v19 row_newbcast:4 row_mask:0xf bank_mask:0xf
    s_waitcnt vmcnt(4)
    s_xor_b32 s101, s53, s100
    buffer_load_dwordx4 v[152:155], v1, s[8:11], s101 offen nt
    s_add_u32 s53, s53, 1024
    v_mfma_f32_16x16x32_bf16 v[4:7], v[8:11], v[132:135], v[4:7]
    v_cvt_pk_bf16_f32 v47, v45, v45
    ds_read_b128 v[48:51], v52 offset:12288
    v_add_u32 v52, 0x400, v52
    v_and_b32_dpp v8, v46, v16 row_newbcast:8 row_mask:0xf bank_mask:0xf
    v_and_b32_dpp v9, v46, v17 row_newbcast:8 row_mask:0xf bank_mask:0xf
    v_and_b32_dpp v10, v46, v18 row_newbcast:8 row_mask:0xf bank_mask:0xf
    v_and_b32_dpp v11, v46, v19 row_newbcast:8 row_mask:0xf bank_mask:0xf
    s_waitcnt vmcnt(4)
    s_xor_b32 s101, s53, s100
    buffer_load_dwordx4 v[156:159], v1, s[8:11], s101 offen nt
    s_add_u32 s53, s53, 13312
    v_mfma_f32_16x16x32_bf16 v[4:7], v[8:11], v[136:139], v[4:7]
    v_and_b32_dpp v8, v46, v16 row_newbcast:12 row_mask:0xf bank_mask:0xf
    v_and_b32_dpp v9, v46, v17 row_newbcast:12 row_mask:0xf bank_mask:0xf
    v_and_b32_dpp v10, v46, v18 row_newbcast:12 row_mask:0xf bank_mask:0xf
    v_and_b32_dpp v11, v46, v19 row_newbcast:12 row_mask:0xf bank_mask:0xf
    s_waitcnt vmcnt(4)
    s_xor_b32 s101, s53, s100
    buffer_load_dwordx4 v[96:99], v1, s[8:11], s101 offen nt
    s_add_u32 s53, s53, 1024
    v_mfma_f32_16x16x32_bf16 v[4:7], v[8:11], v[140:143], v[4:7]
    v_add_f32 v30, v30, v45
    v_and_b32_dpp v8, v47, v16 row_newbcast:0 row_mask:0xf bank_mask:0xf
    v_and_b32_dpp v9, v47, v17 row_newbcast:0 row_mask:0xf bank_mask:0xf
    v_and_b32_dpp v10, v47, v18 row_newbcast:0 row_mask:0xf bank_mask:0xf
    v_and_b32_dpp v11, v47, v19 row_newbcast:0 row_mask:0xf bank_mask:0xf
    s_waitcnt vmcnt(4)
    s_xor_b32 s101, s53, s100
    buffer_load_dwordx4 v[100:103], v1, s[8:11], s101 offen nt
    s_add_u32 s53, s53, 1024
    v_mfma_f32_16x16x32_bf16 v[4:7], v[8:11], v[144:147], v[4:7]
    s_waitcnt lgkmcnt(0)
    v_fma_f32 v32, v48, s57, -v29
    v_exp_f32 v44, v32
    v_and_b32_dpp v8, v47, v16 row_newbcast:4 row_mask:0xf bank_mask:0xf
    v_and_b32_dpp v9, v47, v17 row_newbcast:4 row_mask:0xf bank_mask:0xf
    v_and_b32_dpp v10, v47, v18 row_newbcast:4 row_mask:0xf bank_mask:0xf
    v_and_b32_dpp v11, v47, v19 row_newbcast:4 row_mask:0xf bank_mask:0xf
    s_waitcnt vmcnt(4)
    s_xor_b32 s101, s53, s100
    buffer_load_dwordx4 v[104:107], v1, s[8:11], s101 offen nt
    s_add_u32 s53, s53, 1024
    v_mfma_f32_16x16x32_bf16 v[4:7], v[8:11], v[148:151], v[4:7]
    v_cvt_pk_bf16_f32 v46, v44, v44
    v_and_b32_dpp v8, v47, v16 row_newbcast:8 row_mask:0xf bank_mask:0xf
    v_and_b32_dpp v9, v47, v17 row_newbcast:8 row_mask:0xf bank_mask:0xf
    v_and_b32_dpp v10, v47, v18 row_newbcast:8 row_mask:0xf bank_mask:0xf
    v_and_b32_dpp v11, v47, v19 row_newbcast:8 row_mask:0xf bank_mask:0xf
    s_waitcnt vmcnt(4)
    s_xor_b32 s101, s53, s100
    buffer_load_dwordx4 v[108:111], v1, s[8:11], s101 offen nt
    s_add_u32 s53, s53, 13312
    v_mfma_f32_16x16x32_bf16 v[4:7], v[8:11], v[152:155], v[4:7]
    v_and_b32_dpp v8, v47, v16 row_newbcast:12 row_mask:0xf bank_mask:0xf
    v_and_b32_dpp v9, v47, v17 row_newbcast:12 row_mask:0xf bank_mask:0xf
    v_and_b32_dpp v10, v47, v18 row_newbcast:12 row_mask:0xf bank_mask:0xf
    v_and_b32_dpp v11, v47, v19 row_newbcast:12 row_mask:0xf bank_mask:0xf
    s_waitcnt vmcnt(4)
    s_xor_b32 s101, s53, s100
    buffer_load_dwordx4 v[112:115], v1, s[8:11], s101 offen nt
    s_add_u32 s53, s53, 1024
    v_mfma_f32_16x16x32_bf16 v[4:7], v[8:11], v[156:159], v[4:7]
    s_sub_u32 s54, s54, 1
    s_cmp_lg_u32 s54, 0
    s_cbranch_scc1 L_loop2
    s_branch L_loop2_end
L_loop2_down:
    s_mov_b32 s88, 0
    v_add_f32 v30, v30, v44
    v_and_b32_dpp v8, v46, v16 row_newbcast:0 row_mask:0xf bank_mask:0xf
    v_and_b32_dpp v9, v46, v17 row_newbcast:0 row_mask:0xf bank_mask:0xf
    v_and_b32_dpp v10, v46, v18 row_newbcast:0 row_mask:0xf bank_mask:0xf
    v_and_b32_dpp v11, v46, v19 row_newbcast:0 row_mask:0xf bank_mask:0xf
    s_waitcnt vmcnt(7)
    s_nop 0
    v_mfma_f32_16x16x32_bf16 v[4:7], v[8:11], v[96:99], v[4:7]
    s_branch L_loop2_lo1
L_loop2_up:
    s_cmp_lg_u32 s88, 0
    s_cbranch_scc1 L_loop2_hi
    s_mov_b32 s88, 1
    s_xor_b32 s101, s53, s100
    buffer_load_dwordx4 v[116:119], v1, s[8:11], s101 offen nt
    s_add_u32 s53, s53, 1024
L_loop2_hi:
    v_add_f32 v30, v30, v44
    v_and_b32_dpp v8, v46, v16 row_newbcast:0 row_mask:0xf bank_mask:0xf
    v_and_b32_dpp v9, v46, v17 row_newbcast:0 row_mask:0xf bank_mask:0xf
    v_and_b32_dpp v10, v46, v18 row_newbcast:0 row_mask:0xf bank_mask:0xf
    v_and_b32_dpp v11, v46, v19 row_newbcast:0 row_mask:0xf bank_mask:0xf
    s_waitcnt vmcnt(7)
    s_xor_b32 s101, s53, s100
    buffer_load_dwordx4 v[120:123], v1, s[8:11], s101 offen nt
    s_add_u32 s53, s53, 1024
    v_mfma_f32_16x16x32_bf16 v[4:7], v[8:11], v[96:99], v[4:7]
    v_fma_f32 v32, v49, s57, -v29
    v_exp_f32 v45, v32
    v_and_b32_dpp v8, v46, v16 row_newbcast:4 row_mask:0xf bank_mask:0xf
    v_and_b32_dpp v9, v46, v17 row_newbcast:4 row_mask:0xf bank_mask:0xf
    v_and_b32_dpp v10, v46, v18 row_newbcast:4 row_mask:0xf bank_mask:0xf
    v_and_b32_dpp v11, v46, v19 row_newbcast:4 row_mask:0xf bank_mask:0xf
    s_waitcnt vmcnt(7)
    s_xor_b32 s101, s53, s100
    buffer_load_dwordx4 v[124:127], v1, s[8:11], s101 offen nt
    s_add_u32 s53, s53, 13312
    v_mfma_f32_16x16x32_bf16 v[4:7], v[8:11], v[100:103], v[4:7]
    v_cvt_pk_bf16_f32 v47, v45, v45
    v_and_b32_dpp v8, v46, v16 row_newbcast:8 row_mask:0xf bank_mask:0xf
    v_and_b32_dpp v9, v46, v17 row_newbcast:8 row_mask:0xf bank_mask:0xf
    v_and_b32_dpp v10, v46, v18 row_newbcast:8 row_mask:0xf bank_mask:0xf
    v_and_b32_dpp v11, v46, v19 row_newbcast:8 row_mask:0xf bank_mask:0xf
    s_waitcnt vmcnt(7)
    s_xor_b32 s101, s53, s100
    buffer_load_dwordx4 v[128:131], v1, s[8:11], s101 offen nt
    s_add_u32 s53, s53, 1024
    v_mfma_f32_16x16x32_bf16 v[4:7], v[8:11], v[104:107], v[4:7]
    v_and_b32_dpp v8, v46, v16 row_newbcast:12 row_mask:0xf bank_mask:0xf
    v_and_b32_dpp v9, v46, v17 row_newbcast:12 row_mask:0xf bank_mask:0xf
    v_and_b32_dpp v10, v46, v18 row_newbcast:12 row_mask:0xf bank_mask:0xf
    v_and_b32_dpp v11, v46, v19 row_newbcast:12 row_mask:0xf bank_mask:0xf
    s_waitcnt vmcnt(7)
    s_xor_b32 s101, s53, s100
    buffer_load_dwordx4 v[132:135], v1, s[8:11], s101 offen nt
    s_add_u32 s53, s53, 1024
    v_mfma_f32_16x16x32_bf16 v[4:7], v[8:11], v[108:111], v[4:7]
    v_add_f32 v30, v30, v45
    v_and_b32_dpp v8, v47, v16 row_newbcast:0 row_mask:0xf bank_mask:0xf
    v_and_b32_dpp v9, v47, v17 row_newbcast:0 row_mask:0xf bank_mask:0xf
    v_and_b32_dpp v10, v47, v18 row_newbcast:0 row_mask:0xf bank_mask:0xf
    v_and_b32_dpp v11, v47, v19 row_newbcast:0 row_mask:0xf bank_mask:0xf
    s_waitcnt vmcnt(7)
    s_xor_b32 s101, s53, s100
    buffer_load_dwordx4 v[136:139], v1, s[8:11], s101 offen nt
    s_add_u32 s53, s53, 1024
    v_mfma_f32_16x16x32_bf16 v[4:7], v[8:11], v[112:115], v[4:7]
    v_fma_f32 v32, v50, s57, -v29
    v_exp_f32 v44, v32
    v_and_b32_dpp v8, v47, v16 row_newbcast:4 row_mask:0xf bank_mask:0xf
    v_and_b32_dpp v9, v47, v17 row_newbcast:4 row_mask:0xf bank_mask:0xf
    v_and_b32_dpp v10, v47, v18 row_newbcast:4 row_mask:0xf bank_mask:0xf
    v_and_b32_dpp v11, v47, v19 row_newbcast:4 row_mask:0xf bank_mask:0xf
    s_waitcnt vmcnt(5)
    s_xor_b32 s101, s53, s100
    buffer_load_dwordx4 v[140:143], v1, s[8:11], s101 offen nt
    s_add_u32 s53, s53, 13312
    v_mfma_f32_16x16x32_bf16 v[4:7], v[8:11], v[116:119], v[4:7]
    v_cvt_pk_bf16_f32 v46, v44, v44
    v_and_b32_dpp v8, v47, v16 row_newbcast:8 row_mask:0xf bank_mask:0xf
    v_and_b32_dpp v9, v47, v17 row_newbcast:8 row_mask:0xf bank_mask:0xf
    v_and_b32_dpp v10, v47, v18 row_newbcast:8 row_mask:0xf bank_mask:0xf
    v_and_b32_dpp v11, v47, v19 row_newbcast:8 row_mask:0xf bank_mask:0xf
    s_waitcnt vmcnt(5)
    s_xor_b32 s101, s53, s100
    buffer_load_dwordx4 v[144:147], v1, s[8:11], s101 offen nt
    s_add_u32 s53, s53, 1024
    v_mfma_f32_16x16x32_bf16 v[4:7], v[8:11], v[120:123], v[4:7]
    v_and_b32_dpp v8, v47, v16 row_newbcast:12 row_mask:0xf bank_mask:0xf
    v_and_b32_dpp v9, v47, v17 row_newbcast:12 row_mask:0xf bank_mask:0xf
    v_and_b32_dpp v10, v47, v18 row_newbcast:12 row_mask:0xf bank_mask:0xf
    v_and_b32_dpp v11, v47, v19 row_newbcast:12 row_mask:0xf bank_mask:0xf
    s_waitcnt vmcnt(5)
    s_xor_b32 s101, s53, s100
    buffer_load_dwordx4 v[148:151], v1, s[8:11], s101 offen nt
    s_add_u32 s53, s53, 1024
    v_mfma_f32_16x16x32_bf16 v[4:7], v[8:11], v[124:127], v[4:7]
    v_add_f32 v30, v30, v44
    v_and_b32_dpp v8, v46, v16 row_newbcast:0 row_mask:0xf bank_mask:0xf
    v_and_b32_dpp v9, v46, v17 row_newbcast:0 row_mask:0xf bank_mask:0xf
    v_and_b32_dpp v10, v46, v18 row_newbcast:0 row_mask:0xf bank_mask:0xf
    v_and_b32_dpp v11, v46, v19 row_newbcast:0 row_mask:0xf bank_mask:0xf
    s_waitcnt vmcnt(5)
    s_xor_b32 s101, s53, s100
    buffer_load_dwordx4 v[152:155], v1, s[8:11], s101 offen nt
    s_add_u32 s53, s53, 1024
    v_mfma_f32_16x16x32_bf16 v[4:7], v[8:11], v[128:131], v[4:7]
    v_fma_f32 v32, v51, s57, -v29
    v_exp_f32 v45, v32
    v_and_b32_dpp v8, v46, v16 row_newbcast:4 row_mask:0xf bank_mask:0xf
    v_and_b32_dpp v9, v46, v17 row_newbcast:4 row_mask:0xf bank_mask:0xf
    v_and_b32_dpp v10, v46, v18 row_newbcast:4 row_mask:0xf bank_mask:0xf
    v_and_b32_dpp v11, v46, v19 row_newbcast:4 row_mask:0xf bank_mask:0xf
    s_waitcnt vmcnt(5)
    s_xor_b32 s101, s53, s100
    buffer_load_dwordx4 v[156:159], v1, s[8:11], s101 offen nt
    s_add_u32 s53, s53, 13312
    v_mfma_f32_16x16x32_bf16 v[4:7], v[8:11], v[132:135], v[4:7]
    v_cvt_pk_bf16_f32 v47, v45, v45
    ds_read_b128 v[48:51], v52 offset:12288
    v_add_u32 v52, 0x400, v52
    v_and_b32_dpp v8, v46, v16 row_newbcast:8 row_mask:0xf bank_mask:0xf
    v_and_b32_dpp v9, v46, v17 row_newbcast:8 row_mask:0xf bank_mask:0xf
    v_and_b32_dpp v10, v46, v18 row_newbcast:8 row_mask:0xf bank_mask:0xf
    v_and_b32_dpp v11, v46, v19 row_newbcast:8 row_mask:0xf bank_mask:0xf
    s_waitcnt vmcnt(5)
    s_xor_b32 s101, s53, s100
    buffer_load_dwordx4 v[96:99], v1, s[8:11], s101 offen nt
    s_add_u32 s53, s53, 1024
    v_mfma_f32_16x16x32_bf16 v[4:7], v[8:11], v[136:139], v[4:7]
    v_and_b32_dpp v8, v46, v16 row_newbcast:12 row_mask:0xf bank_mask:0xf
    v_and_b32_dpp v9, v46, v17 row_newbcast:12 row_mask:0xf bank_mask:0xf
    v_and_b32_dpp v10, v46, v18 row_newbcast:12 row_mask:0xf bank_mask:0xf
    v_and_b32_dpp v11, v46, v19 row_newbcast:12 row_mask:0xf bank_mask:0xf
    s_waitcnt vmcnt(5)
    s_xor_b32 s101, s53, s100
    buffer_load_dwordx4 v[100:103], v1, s[8:11], s101 offen nt
    s_add_u32 s53, s53, 1024
    v_mfma_f32_16x16x32_bf16 v[4:7], v[8:11], v[140:143], v[4:7]
    v_add_f32 v30, v30, v45
    v_and_b32_dpp v8, v47, v16 row_newbcast:0 row_mask:0xf bank_mask:0xf
    v_and_b32_dpp v9, v47, v17 row_newbcast:0 row_mask:0xf bank_mask:0xf
    v_and_b32_dpp v10, v47, v18 row_newbcast:0 row_mask:0xf bank_mask:0xf
    v_and_b32_dpp v11, v47, v19 row_newbcast:0 row_mask:0xf bank_mask:0xf
    s_waitcnt vmcnt(5)
    s_xor_b32 s101, s53, s100
    buffer_load_dwordx4 v[104:107], v1, s[8:11], s101 offen nt
    s_add_u32 s53, s53, 1024
    v_mfma_f32_16x16x32_bf16 v[4:7], v[8:11], v[144:147], v[4:7]
    s_waitcnt lgkmcnt(0)
    v_fma_f32 v32, v48, s57, -v29
    v_exp_f32 v44, v32
    v_and_b32_dpp v8, v47, v16 row_newbcast:4 row_mask:0xf bank_mask:0xf
    v_and_b32_dpp v9, v47, v17 row_newbcast:4 row_mask:0xf bank_mask:0xf
    v_and_b32_dpp v10, v47, v18 row_newbcast:4 row_mask:0xf bank_mask:0xf
    v_and_b32_dpp v11, v47, v19 row_newbcast:4 row_mask:0xf bank_mask:0xf
    s_waitcnt vmcnt(5)
    s_xor_b32 s101, s53, s100
    buffer_load_dwordx4 v[108:111], v1, s[8:11], s101 offen nt
    s_add_u32 s53, s53, 13312
    v_mfma_f32_16x16x32_bf16 v[4:7], v[8:11], v[148:151], v[4:7]
    v_cvt_pk_bf16_f32 v46, v44, v44
    v_and_b32_dpp v8, v47, v16 row_newbcast:8 row_mask:0xf bank_mask:0xf
    v_and_b32_dpp v9, v47, v17 row_newbcast:8 row_mask:0xf bank_mask:0xf
    v_and_b32_dpp v10, v47, v18 row_newbcast:8 row_mask:0xf bank_mask:0xf
    v_and_b32_dpp v11, v47, v19 row_newbcast:8 row_mask:0xf bank_mask:0xf
    s_waitcnt vmcnt(5)
    s_xor_b32 s101, s53, s100
    buffer_load_dwordx4 v[112:115], v1, s[8:11], s101 offen nt
    s_add_u32 s53, s53, 1024
    v_mfma_f32_16x16x32_bf16 v[4:7], v[8:11], v[152:155], v[4:7]
    v_and_b32_dpp v8, v47, v16 row_newbcast:12 row_mask:0xf bank_mask:0xf
    v_and_b32_dpp v9, v47, v17 row_newbcast:12 row_mask:0xf bank_mask:0xf
    v_and_b32_dpp v10, v47, v18 row_newbcast:12 row_mask:0xf bank_mask:0xf
    v_and_b32_dpp v11, v47, v19 row_newbcast:12 row_mask:0xf bank_mask:0xf
    s_waitcnt vmcnt(5)
    s_xor_b32 s101, s53, s100
    buffer_load_dwordx4 v[116:119], v1, s[8:11], s101 offen nt
    s_add_u32 s53, s53, 1024
    v_mfma_f32_16x16x32_bf16 v[4:7], v[8:11], v[156:159], v[4:7]
    s_sub_u32 s54, s54, 1
    s_cmp_lg_u32 s54, 0
    s_cbranch_scc1 L_loop2
L_loop2_end:
    s_cmp_lg_u32 s88, 0
    s_cbranch_scc1 L_tail
    s_xor_b32 s101, s53, s100
    buffer_load_dwordx4 v[116:119], v1, s[8:11], s101 offen nt
    s_add_u32 s53, s53, 1024
L_tail:
    v_add_f32 v30, v30, v44
    v_and_b32_dpp v8, v46, v16 row_newbcast:0 row_mask:0xf bank_mask:0xf
    v_and_b32_dpp v9, v46, v17 row_newbcast:0 row_mask:0xf bank_mask:0xf
    v_and_b32_dpp v10, v46, v18 row_newbcast:0 row_mask:0xf bank_mask:0xf
    v_and_b32_dpp v11, v46, v19 row_newbcast:0 row_mask:0xf bank_mask:0xf
    s_waitcnt vmcnt(5)
    s_xor_b32 s101, s53, s100
    buffer_load_dwordx4 v[120:123], v1, s[8:11], s101 offen nt
    s_add_u32 s53, s53, 1024
    s_xor_b32 s101, s53, s100
    buffer_load_dwordx4 v[124:127], v1, s[8:11], s101 offen nt
    s_add_u32 s53, s53, 13312
    v_mfma_f32_16x16x32_bf16 v[4:7], v[8:11], v[96:99], v[4:7]
    v_fma_f32 v32, v49, s57, -v29
    v_exp_f32 v45, v32
    v_and_b32_dpp v8, v46, v16 row_newbcast:4 row_mask:0xf bank_mask:0xf
    v_and_b32_dpp v9, v46, v17 row_newbcast:4 row_mask:0xf bank_mask:0xf
    v_and_b32_dpp v10, v46, v18 row_newbcast:4 row_mask:0xf bank_mask:0xf
    v_and_b32_dpp v11, v46, v19 row_newbcast:4 row_mask:0xf bank_mask:0xf
    s_waitcnt vmcnt(6)
    s_xor_b32 s101, s53, s100
    buffer_load_dwordx4 v[96:99], v1, s[8:11], s101 offen nt
    s_add_u32 s53, s53, 1024
    s_xor_b32 s101, s53, s100
    buffer_load_dwordx4 v[128:131], v1, s[8:11], s101 offen nt
    s_add_u32 s53, s53, 1024
    v_mfma_f32_16x16x32_bf16 v[4:7], v[8:11], v[100:103], v[4:7]
    v_cvt_pk_bf16_f32 v47, v45, v45
    v_and_b32_dpp v8, v46, v16 row_newbcast:8 row_mask:0xf bank_mask:0xf
    v_and_b32_dpp v9, v46, v17 row_newbcast:8 row_mask:0xf bank_mask:0xf
    v_and_b32_dpp v10, v46, v18 row_newbcast:8 row_mask:0xf bank_mask:0xf
    v_and_b32_dpp v11, v46, v19 row_newbcast:8 row_mask:0xf bank_mask:0xf
    s_waitcnt vmcnt(7)
    s_xor_b32 s101, s53, s100
    buffer_load_dwordx4 v[100:103], v1, s[8:11], s101 offen nt
    s_add_u32 s53, s53, 1024
    s_xor_b32 s101, s53, s100
    buffer_load_dwordx4 v[132:135], v1, s[8:11], s101 offen nt
    s_add_u32 s53, s53, 13312
    v_mfma_f32_16x16x32_bf16 v[4:7], v[8:11], v[104:107], v[4:7]
    v_and_b32_dpp v8, v46, v16 row_newbcast:12 row_mask:0xf bank_mask:0xf
    v_and_b32_dpp v9, v46, v17 row_newbcast:12 row_mask:0xf bank_mask:0xf
    v_and_b32_dpp v10, v46, v18 row_newbcast:12 row_mask:0xf bank_mask:0xf
    v_and_b32_dpp v11, v46, v19 row_newbcast:12 row_mask:0xf bank_mask:0xf
    s_waitcnt vmcnt(8)
    s_xor_b32 s101, s53, s100
    buffer_load_dwordx4 v[104:107], v1, s[8:11], s101 offen nt
    s_add_u32 s53, s53, 1024
    s_xor_b32 s101, s53, s100
    buffer_load_dwordx4 v[136:139], v1, s[8:11], s101 offen nt
    s_add_u32 s53, s53, 1024
    v_mfma_f32_16x16x32_bf16 v[4:7], v[8:11], v[108:111], v[4:7]
    v_add_f32 v30, v30, v45
    v_and_b32_dpp v8, v47, v16 row_newbcast:0 row_mask:0xf bank_mask:0xf
    v_and_b32_dpp v9, v47, v17 row_newbcast:0 row_mask:0xf bank_mask:0xf
    v_and_b32_dpp v10, v47, v18 row_newbcast:0 row_mask:0xf bank_mask:0xf
    v_and_b32_dpp v11, v47, v19 row_newbcast:0 row_mask:0xf bank_mask:0xf
    s_waitcnt vmcnt(9)
    s_xor_b32 s101, s53, s100
    buffer_load_dwordx4 v[108:111], v1, s[8:11], s101 offen nt
    s_add_u32 s53, s53, 1024
    s_xor_b32 s101, s53, s100
    buffer_load_dwordx4 v[140:143], v1, s[8:11], s101 offen nt
    s_add_u32 s53, s53, 13312
    v_mfma_f32_16x16x32_bf16 v[4:7], v[8:11], v[112:115], v[4:7]
    v_fma_f32 v32, v50, s57, -v29
    v_exp_f32 v44, v32
    v_and_b32_dpp v8, v47, v16 row_newbcast:4 row_mask:0xf bank_mask:0xf
    v_and_b32_dpp v9, v47, v17 row_newbcast:4 row_mask:0xf bank_mask:0xf
    v_and_b32_dpp v10, v47, v18 row_newbcast:4 row_mask:0xf bank_mask:0xf
    v_and_b32_dpp v11, v47, v19 row_newbcast:4 row_mask:0xf bank_mask:0xf
    s_waitcnt vmcnt(10)
    s_nop 0
    v_mfma_f32_16x16x32_bf16 v[4:7], v[8:11], v[116:119], v[4:7]
    v_cvt_pk_bf16_f32 v46, v44, v44
    v_and_b32_dpp v8, v47, v16 row_newbcast:8 row_mask:0xf bank_mask:0xf
    v_and_b32_dpp v9, v47, v17 row_newbcast:8 row_mask:0xf bank_mask:0xf
    v_and_b32_dpp v10, v47, v18 row_newbcast:8 row_mask:0xf bank_mask:0xf
    v_and_b32_dpp v11, v47, v19 row_newbcast:8 row_mask:0xf bank_mask:0xf
    s_waitcnt vmcnt(9)
    s_nop 0
    v_mfma_f32_16x16x32_bf16 v[4:7], v[8:11], v[120:123], v[4:7]
    v_and_b32_dpp v8, v47, v16 row_newbcast:12 row_mask:0xf bank_mask:0xf
    v_and_b32_dpp v9, v47, v17 row_newbcast:12 row_mask:0xf bank_mask:0xf
    v_and_b32_dpp v10, v47, v18 row_newbcast:12 row_mask:0xf bank_mask:0xf
    v_and_b32_dpp v11, v47, v19 row_newbcast:12 row_mask:0xf bank_mask:0xf
    s_waitcnt vmcnt(8)
    s_nop 0
    v_mfma_f32_16x16x32_bf16 v[4:7], v[8:11], v[124:127], v[4:7]
    v_add_f32 v30, v30, v44
    v_and_b32_dpp v8, v46, v16 row_newbcast:0 row_mask:0xf bank_mask:0xf
    v_and_b32_dpp v9, v46, v17 row_newbcast:0 row_mask:0xf bank_mask:0xf
    v_and_b32_dpp v10, v46, v18 row_newbcast:0 row_mask:0xf bank_mask:0xf
    v_and_b32_dpp v11, v46, v19 row_newbcast:0 row_mask:0xf bank_mask:0xf
    s_waitcnt vmcnt(7)
    s_nop 0
    v_mfma_f32_16x16x32_bf16 v[4:7], v[8:11], v[96:99], v[4:7]
    v_fma_f32 v32, v51, s57, -v29
    v_exp_f32 v45, v32
    v_and_b32_dpp v8, v46, v16 row_newbcast:4 row_mask:0xf bank_mask:0xf
    v_and_b32_dpp v9, v46, v17 row_newbcast:4 row_mask:0xf bank_mask:0xf
    v_and_b32_dpp v10, v46, v18 row_newbcast:4 row_mask:0xf bank_mask:0xf
    v_and_b32_dpp v11, v46, v19 row_newbcast:4 row_mask:0xf bank_mask:0xf
    s_waitcnt vmcnt(6)
    s_nop 0
    v_mfma_f32_16x16x32_bf16 v[4:7], v[8:11], v[128:131], v[4:7]
    v_cvt_pk_bf16_f32 v47, v45, v45
    v_and_b32_dpp v8, v46, v16 row_newbcast:8 row_mask:0xf bank_mask:0xf
    v_and_b32_dpp v9, v46, v17 row_newbcast:8 row_mask:0xf bank_mask:0xf
    v_and_b32_dpp v10, v46, v18 row_newbcast:8 row_mask:0xf bank_mask:0xf
    v_and_b32_dpp v11, v46, v19 row_newbcast:8 row_mask:0xf bank_mask:0xf
    s_waitcnt vmcnt(5)
    s_nop 0
    v_mfma_f32_16x16x32_bf16 v[4:7], v[8:11], v[100:103], v[4:7]
    v_and_b32_dpp v8, v46, v16 row_newbcast:12 row_mask:0xf bank_mask:0xf
    v_and_b32_dpp v9, v46, v17 row_newbcast:12 row_mask:0xf bank_mask:0xf
    v_and_b32_dpp v10, v46, v18 row_newbcast:12 row_mask:0xf bank_mask:0xf
    v_and_b32_dpp v11, v46, v19 row_newbcast:12 row_mask:0xf bank_mask:0xf
    s_waitcnt vmcnt(4)
    s_nop 0
    v_mfma_f32_16x16x32_bf16 v[4:7], v[8:11], v[132:135], v[4:7]
    v_add_f32 v30, v30, v45
    v_and_b32_dpp v8, v47, v16 row_newbcast:0 row_mask:0xf bank_mask:0xf
    v_and_b32_dpp v9, v47, v17 row_newbcast:0 row_mask:0xf bank_mask:0xf
    v_and_b32_dpp v10, v47, v18 row_newbcast:0 row_mask:0xf bank_mask:0xf
    v_and_b32_dpp v11, v47, v19 row_newbcast:0 row_mask:0xf bank_mask:0xf
    s_waitcnt vmcnt(3)
    s_nop 0
    v_mfma_f32_16x16x32_bf16 v[4:7], v[8:11], v[104:107], v[4:7]
    v_add_f32_dpp v30, v30, v30 row_ror:8 row_mask:0xf bank_mask:0xf
    s_nop 1
    v_add_f32_dpp v30, v30, v30 row_ror:4 row_mask:0xf bank_mask:0xf
    v_mov_b32 v32, v30
    s_nop 1
    v_permlane16_swap_b32 v30, v32
    v_add_f32 v30, v30, v32
    v_mov_b32 v32, v30
    s_nop 1
    v_permlane32_swap_b32 v30, v32
    v_add_f32 v30, v30, v32
    ds_write_b32 v33, v30 offset:8208
    v_mov_b32 v30, v75
    v_mov_b32 v31, v75
    v_and_b32_dpp v8, v47, v16 row_newbcast:4 row_mask:0xf bank_mask:0xf
    v_and_b32_dpp v9, v47, v17 row_newbcast:4 row_mask:0xf bank_mask:0xf
    v_and_b32_dpp v10, v47, v18 row_newbcast:4 row_mask:0xf bank_mask:0xf
    v_and_b32_dpp v11, v47, v19 row_newbcast:4 row_mask:0xf bank_mask:0xf
    s_waitcnt vmcnt(2)
    s_nop 0
    v_mfma_f32_16x16x32_bf16 v[4:7], v[8:11], v[136:139], v[4:7]
    v_and_b32_dpp v8, v47, v16 row_newbcast:8 row_mask:0xf bank_mask:0xf
    v_and_b32_dpp v9, v47, v17 row_newbcast:8 row_mask:0xf bank_mask:0xf
    v_and_b32_dpp v10, v47, v18 row_newbcast:8 row_mask:0xf bank_mask:0xf
    v_and_b32_dpp v11, v47, v19 row_newbcast:8 row_mask:0xf bank_mask:0xf
    s_waitcnt vmcnt(1)
    s_nop 0
    v_mfma_f32_16x16x32_bf16 v[4:7], v[8:11], v[108:111], v[4:7]
    v_and_b32_dpp v8, v47, v16 row_newbcast:12 row_mask:0xf bank_mask:0xf
    v_and_b32_dpp v9, v47, v17 row_newbcast:12 row_mask:0xf bank_mask:0xf
    v_and_b32_dpp v10, v47, v18 row_newbcast:12 row_mask:0xf bank_mask:0xf
    v_and_b32_dpp v11, v47, v19 row_newbcast:12 row_mask:0xf bank_mask:0xf
    s_waitcnt vmcnt(0)
    s_nop 0
    v_mfma_f32_16x16x32_bf16 v[4:7], v[8:11], v[140:143], v[4:7]
    s_nop 7
    ds_write_b128 v34, v[4:7] offset:6144
    s_waitcnt lgkmcnt(0)
    s_barrier
    ds_read_b64 v[40:41], v56 offset:6144
    ds_read_b64 v[42:43], v56 offset:6656
    ds_read_b64 v[44:45], v56 offset:7168
    ds_read_b64 v[46:47], v56 offset:7680
    ds_read_b128 v[48:51], v59 offset:8208
    s_waitcnt lgkmcnt(3)
    v_add_f32 v82, v40, v42
    v_add_f32 v83, v41, v43
    s_waitcnt lgkmcnt(1)
    v_add_f32 v44, v44, v46
    v_add_f32 v45, v45, v47
    v_add_f32 v82, v82, v44
    v_add_f32 v83, v83, v45
    v_cvt_pk_bf16_f32 v84, v82, v83
    ds_write_b32 v57, v84 offset:8448
    v_lshlrev_b32 v86, 16, v84
    v_and_b32 v87, s66, v84
    v_sub_f32 v82, v82, v86
    v_sub_f32 v83, v83, v87
    v_cvt_pk_bf16_f32 v85, v82, v83
    ds_write_b32 v57, v85 offset:8704
    s_waitcnt lgkmcnt(2)
    v_add_f32 v80, v48, v49
    v_add_f32 v81, v50, v51
    ds_read_b128 v[40:43], v88 offset:8448
    ds_read_b128 v[44:47], v88 offset:8464
    ds_read_b128 v[48:51], v88 offset:8480
    ds_read_b128 v[52:55], v88 offset:8496
    v_add_f32 v80, v80, v81
    v_bfi_b32 v29, v61, v60, v80
    s_cmp_lg_u32 s3, 3
    s_cbranch_scc1 L_norec
    s_mov_b64 exec, 1
    buffer_store_dwordx4 v[28:31], v59, s[44:47], s69 offen sc1
    s_mov_b64 exec, -1
L_norec:
    s_waitcnt lgkmcnt(0)
    s_call_b64 s[48:49], L_gemv
    v_mov_b32 v80, v36
    v_mov_b32 v81, v37
    v_mov_b32 v82, v38
    v_mov_b32 v83, v39
    v_permlane32_swap_b32 v36, v80
    v_permlane32_swap_b32 v37, v81
    v_permlane32_swap_b32 v38, v82
    v_permlane32_swap_b32 v39, v83
    v_add_f32 v36, v36, v80
    v_add_f32 v37, v37, v81
    v_add_f32 v38, v38, v82
    v_add_f32 v39, v39, v83
    v_bfi_b32 v36, v61, v60, v36
    v_bfi_b32 v37, v61, v60, v37
    v_bfi_b32 v38, v61, v60, v38
    v_bfi_b32 v39, v61, v60, v39
    s_mov_b32 exec_hi, 0
    buffer_store_dwordx4 v[36:39], v35, s[44:47], s67 offen sc1
    s_mov_b32 exec_hi, -1
    s_cmp_ge_u32 s2, 32
    s_cbranch_scc1 L_fin
    buffer_load_dwordx4 v[96:99], v62, s[44:47], s62 offen sc1
    buffer_load_dwordx4 v[100:103], v62, s[44:47], s63 offen sc1
    buffer_load_dwordx4 v[104:107], v62, s[44:47], s64 offen sc1
    buffer_load_dwordx4 v[108:111], v62, s[44:47], s65 offen sc1
    buffer_load_dwordx4 v[128:131], v63, s[44:47], s84 offen sc1
    buffer_load_dwordx4 v[132:135], v63, s[44:47], s85 offen sc1
    buffer_load_dwordx4 v[136:139], v63, s[44:47], s86 offen sc1
    buffer_load_dwordx4 v[140:143], v63, s[44:47], s87 offen sc1
    buffer_load_dword v144, v66, s[44:47], s76 offen sc1
    s_mov_b32 s54, 1048576
    s_mov_b32 s78, 0
    s_mov_b64 s[82:83], -1
    s_branch L_coef
L_wait:
    s_waitcnt vmcnt(5)
    v_xor_b32 v168, v60, v96
    v_xor_b32 v169, v60, v97
    v_xor_b32 v170, v60, v98
    v_xor_b32 v171, v60, v99
    v_xor_b32 v172, v60, v100
    v_xor_b32 v173, v60, v101
    v_xor_b32 v174, v60, v102
    v_xor_b32 v175, v60, v103
    v_xor_b32 v176, v60, v104
    v_xor_b32 v177, v60, v105
    v_xor_b32 v178, v60, v106
    v_xor_b32 v179, v60, v107
    v_xor_b32 v180, v60, v108
    v_xor_b32 v181, v60, v109
    v_xor_b32 v182, v60, v110
    v_xor_b32 v183, v60, v111
    v_or3_b32 v206, v168, v169, v170
    v_or3_b32 v207, v171, v172, v173
    v_or3_b32 v207, v207, v174, v175
    v_or3_b32 v206, v206, v176, v177
    v_or3_b32 v207, v207, v178, v179
    v_or3_b32 v206, v206, v180, v181
    v_or3_b32 v207, v207, v182, v183
    v_bitop3_b32 v206, v206, v207, v61 bitop3:0xa8
    v_cmp_ne_u32 s[82:83], 0, v206
L_pollm:
    buffer_load_dwordx4 v[148:151], v63, s[44:47], s84 offen sc1
    buffer_load_dwordx4 v[152:155], v63, s[44:47], s85 offen sc1
    buffer_load_dwordx4 v[156:159], v63, s[44:47], s86 offen sc1
    buffer_load_dwordx4 v[160:163], v63, s[44:47], s87 offen sc1
    buffer_load_dword v164, v66, s[44:47], s76 offen sc1
    s_waitcnt vmcnt(5)
    v_xor_b32 v184, v74, v128
    v_xor_b32 v188, v60, v129
    v_xor_b32 v185, v74, v132
    v_xor_b32 v189, v60, v133
    v_xor_b32 v186, v74, v136
    v_xor_b32 v190, v60, v137
    v_xor_b32 v187, v74, v140
    v_xor_b32 v191, v60, v141
    v_xor_b32 v192, v74, v144
    v_or3_b32 v206, v184, v185, v186
    v_or3_b32 v207, v188, v189, v190
    v_or3_b32 v206, v206, v187, v192
    v_bitop3_b32 v207, v207, v191, v61 bitop3:0xa8
    v_lshlrev_b32 v206, 16, v206
    v_bitop3_b32 v206, v206, v130, v75 bitop3:0xf6
    v_bitop3_b32 v207, v207, v131, v75 bitop3:0xf6
    v_bitop3_b32 v206, v206, v134, v75 bitop3:0xf6
    v_bitop3_b32 v207, v207, v135, v75 bitop3:0xf6
    v_bitop3_b32 v206, v206, v138, v75 bitop3:0xf6
    v_bitop3_b32 v207, v207, v139, v75 bitop3:0xf6
    v_bitop3_b32 v206, v206, v142, v75 bitop3:0xf6
    v_bitop3_b32 v207, v207, v143, v75 bitop3:0xf6
    v_or_b32 v206, v206, v207
    v_cmp_ne_u32 s[80:81], 0, v206
    s_mov_b64 exec, s[80:81]
    s_cbranch_execz L_all
    buffer_load_dwordx4 v[128:131], v63, s[44:47], s84 offen sc1
    buffer_load_dwordx4 v[132:135], v63, s[44:47], s85 offen sc1
    buffer_load_dwordx4 v[136:139], v63, s[44:47], s86 offen sc1
    buffer_load_dwordx4 v[140:143], v63, s[44:47], s87 offen sc1
    buffer_load_dword v144, v66, s[44:47], s76 offen sc1
    s_waitcnt vmcnt(5)
    v_xor_b32 v184, v74, v148
    v_xor_b32 v188, v60, v149
    v_xor_b32 v185, v74, v152
    v_xor_b32 v189, v60, v153
    v_xor_b32 v186, v74, v156
    v_xor_b32 v190, v60, v157
    v_xor_b32 v187, v74, v160
    v_xor_b32 v191, v60, v161
    v_xor_b32 v192, v74, v164
    v_or3_b32 v206, v184, v185, v186
    v_or3_b32 v207, v188, v189, v190
    v_or3_b32 v206, v206, v187, v192
    v_bitop3_b32 v207, v207, v191, v61 bitop3:0xa8
    v_lshlrev_b32 v206, 16, v206
    v_bitop3_b32 v206, v206, v150, v75 bitop3:0xf6
    v_bitop3_b32 v207, v207, v151, v75 bitop3:0xf6
    v_bitop3_b32 v206, v206, v154, v75 bitop3:0xf6
    v_bitop3_b32 v207, v207, v155, v75 bitop3:0xf6
    v_bitop3_b32 v206, v206, v158, v75 bitop3:0xf6
    v_bitop3_b32 v207, v207, v159, v75 bitop3:0xf6
    v_bitop3_b32 v206, v206, v162, v75 bitop3:0xf6
    v_bitop3_b32 v207, v207, v163, v75 bitop3:0xf6
    v_or_b32 v206, v206, v207
    v_cmp_ne_u32 s[80:81], 0, v206
    s_mov_b64 exec, s[80:81]
    s_cbranch_execz L_all
    s_sub_u32 s54, s54, 1
    s_cmp_gt_i32 s54, 0
    s_cbranch_scc1 L_pollm
L_all:
    s_mov_b64 exec, s[82:83]
    s_cbranch_execz L_noy
    buffer_load_dwordx4 v[96:99], v62, s[44:47], s62 offen sc1
    buffer_load_dwordx4 v[100:103], v62, s[44:47], s63 offen sc1
    buffer_load_dwordx4 v[104:107], v62, s[44:47], s64 offen sc1
    buffer_load_dwordx4 v[108:111], v62, s[44:47], s65 offen sc1
L_noy:
    s_mov_b64 exec, -1
L_coef:
    v_mul_f32 v194, s57, v184
    v_mul_f32 v195, s57, v185
    v_mul_f32 v196, s57, v186
    v_mul_f32 v197, s57, v187
    v_max_f32_dpp v198, v194, v194 row_ror:4 row_mask:0xf bank_mask:0xf
    v_max_f32_dpp v199, v195, v195 row_ror:4 row_mask:0xf bank_mask:0xf
    v_max_f32_dpp v200, v196, v196 row_ror:4 row_mask:0xf bank_mask:0xf
    v_max_f32_dpp v201, v197, v197 row_ror:4 row_mask:0xf bank_mask:0xf
    v_max_f32_dpp v198, v198, v198 row_ror:8 row_mask:0xf bank_mask:0xf
    v_max_f32_dpp v199, v199, v199 row_ror:8 row_mask:0xf bank_mask:0xf
    v_max_f32_dpp v200, v200, v200 row_ror:8 row_mask:0xf bank_mask:0xf
    v_max_f32_dpp v201, v201, v201 row_ror:8 row_mask:0xf bank_mask:0xf
    v_mov_b32 v202, v198
    v_mov_b32 v203, v199
    v_mov_b32 v204, v200
    v_mov_b32 v205, v201
    v_permlane16_swap_b32 v198, v202
    v_permlane16_swap_b32 v199, v203
    v_permlane16_swap_b32 v200, v204
    v_permlane16_swap_b32 v201, v205
    v_max_f32 v198, v198, v202
    v_max_f32 v199, v199, v203
    v_max_f32 v200, v200, v204
    v_max_f32 v201, v201, v205
    v_sub_f32 v194, v194, v198
    v_sub_f32 v195, v195, v199
    v_sub_f32 v196, v196, v200
    v_sub_f32 v197, v197, v201
    v_exp_f32 v194, v194
    v_exp_f32 v195, v195
    v_exp_f32 v196, v196
    v_exp_f32 v197, v197
    v_mul_f32 v198, v194, v188
    v_mul_f32 v199, v195, v189
    v_mul_f32 v200, v196, v190
    v_mul_f32 v201, v197, v191
    v_add_f32_dpp v198, v198, v198 row_ror:4 row_mask:0xf bank_mask:0xf
    v_add_f32_dpp v199, v199, v199 row_ror:4 row_mask:0xf bank_mask:0xf
    v_add_f32_dpp v200, v200, v200 row_ror:4 row_mask:0xf bank_mask:0xf
    v_add_f32_dpp v201, v201, v201 row_ror:4 row_mask:0xf bank_mask:0xf
    v_add_f32_dpp v198, v198, v198 row_ror:8 row_mask:0xf bank_mask:0xf
    v_add_f32_dpp v199, v199, v199 row_ror:8 row_mask:0xf bank_mask:0xf
    v_add_f32_dpp v200, v200, v200 row_ror:8 row_mask:0xf bank_mask:0xf
    v_add_f32_dpp v201, v201, v201 row_ror:8 row_mask:0xf bank_mask:0xf
    v_mov_b32 v202, v198
    v_mov_b32 v203, v199
    v_mov_b32 v204, v200
    v_mov_b32 v205, v201
    v_permlane16_swap_b32 v198, v202
    v_permlane16_swap_b32 v199, v203
    v_permlane16_swap_b32 v200, v204
    v_permlane16_swap_b32 v201, v205
    v_add_f32 v198, v198, v202
    v_add_f32 v199, v199, v203
    v_add_f32 v200, v200, v204
    v_add_f32 v201, v201, v205
    v_rcp_f32 v198, v198
    v_rcp_f32 v199, v199
    v_rcp_f32 v200, v200
    v_rcp_f32 v201, v201
    v_mul_f32 v194, v194, v198
    v_mul_f32 v195, v195, v199
    v_mul_f32 v196, v196, v200
    v_mul_f32 v197, v197, v201
    s_cmp_eq_u32 s78, 0
    s_cbranch_scc1 L_sum
    s_mov_b64 exec, s[82:83]
    s_cbranch_execz L_got
L_polly:
    buffer_load_dwordx4 v[112:115], v62, s[44:47], s62 offen sc1
    buffer_load_dwordx4 v[116:119], v62, s[44:47], s63 offen sc1
    buffer_load_dwordx4 v[120:123], v62, s[44:47], s64 offen sc1
    buffer_load_dwordx4 v[124:127], v62, s[44:47], s65 offen sc1
    s_waitcnt vmcnt(4)
    v_xor_b32 v168, v60, v96
    v_xor_b32 v169, v60, v97
    v_xor_b32 v170, v60, v98
    v_xor_b32 v171, v60, v99
    v_xor_b32 v172, v60, v100
    v_xor_b32 v173, v60, v101
    v_xor_b32 v174, v60, v102
    v_xor_b32 v175, v60, v103
    v_xor_b32 v176, v60, v104
    v_xor_b32 v177, v60, v105
    v_xor_b32 v178, v60, v106
    v_xor_b32 v179, v60, v107
    v_xor_b32 v180, v60, v108
    v_xor_b32 v181, v60, v109
    v_xor_b32 v182, v60, v110
    v_xor_b32 v183, v60, v111
    v_or3_b32 v206, v168, v169, v170
    v_or3_b32 v207, v171, v172, v173
    v_or3_b32 v207, v207, v174, v175
    v_or3_b32 v206, v206, v176, v177
    v_or3_b32 v207, v207, v178, v179
    v_or3_b32 v206, v206, v180, v181
    v_or3_b32 v207, v207, v182, v183
    v_bitop3_b32 v206, v206, v207, v61 bitop3:0xa8
    v_cmp_ne_u32 s[82:83], 0, v206
    s_mov_b64 exec, s[82:83]
    s_cbranch_execz L_got
    buffer_load_dwordx4 v[96:99], v62, s[44:47], s62 offen sc1
    buffer_load_dwordx4 v[100:103], v62, s[44:47], s63 offen sc1
    buffer_load_dwordx4 v[104:107], v62, s[44:47], s64 offen sc1
    buffer_load_dwordx4 v[108:111], v62, s[44:47], s65 offen sc1
    s_waitcnt vmcnt(4)
    v_xor_b32 v168, v60, v112
    v_xor_b32 v169, v60, v113
    v_xor_b32 v170, v60, v114
    v_xor_b32 v171, v60, v115
    v_xor_b32 v172, v60, v116
    v_xor_b32 v173, v60, v117
    v_xor_b32 v174, v60, v118
    v_xor_b32 v175, v60, v119
    v_xor_b32 v176, v60, v120
    v_xor_b32 v177, v60, v121
    v_xor_b32 v178, v60, v122
    v_xor_b32 v179, v60, v123
    v_xor_b32 v180, v60, v124
    v_xor_b32 v181, v60, v125
    v_xor_b32 v182, v60, v126
    v_xor_b32 v183, v60, v127
    v_or3_b32 v206, v168, v169, v170
    v_or3_b32 v207, v171, v172, v173
    v_or3_b32 v207, v207, v174, v175
    v_or3_b32 v206, v206, v176, v177
    v_or3_b32 v207, v207, v178, v179
    v_or3_b32 v206, v206, v180, v181
    v_or3_b32 v207, v207, v182, v183
    v_bitop3_b32 v206, v206, v207, v61 bitop3:0xa8
    v_cmp_ne_u32 s[82:83], 0, v206
    s_mov_b64 exec, s[82:83]
    s_cbranch_execz L_got
    s_sub_u32 s54, s54, 1
    s_cmp_gt_i32 s54, 0
    s_cbranch_scc1 L_polly
L_got:
    s_mov_b64 exec, -1
L_sum:
    v_mul_f32 v202, v194, v168
    v_mul_f32 v203, v194, v169
    v_mul_f32 v204, v194, v170
    v_mul_f32 v205, v194, v171
    v_fmac_f32 v202, v195, v172
    v_fmac_f32 v203, v195, v173
    v_fmac_f32 v204, v195, v174
    v_fmac_f32 v205, v195, v175
    v_fmac_f32 v202, v196, v176
    v_fmac_f32 v203, v196, v177
    v_fmac_f32 v204, v196, v178
    v_fmac_f32 v205, v196, v179
    v_fmac_f32 v202, v197, v180
    v_fmac_f32 v203, v197, v181
    v_fmac_f32 v204, v197, v182
    v_fmac_f32 v205, v197, v183
    v_permlane32_swap_b32 v202, v203
    s_nop 0
    v_permlane32_swap_b32 v204, v205
    v_add_f32 v202, v202, v203
    v_add_f32 v204, v204, v205
    s_nop 1
    v_permlane16_swap_b32 v202, v204
    v_add_f32 v202, v202, v204
    s_nop 1
    v_add_f32_dpp v202, v202, v202 row_ror:8 row_mask:0xf bank_mask:0xf
    s_nop 1
    v_add_f32_dpp v202, v202, v202 row_ror:4 row_mask:0xf bank_mask:0xf
    ds_write_b32 v67, v202 offset:10496
    s_cmp_eq_u32 s78, 0
    s_mov_b32 s78, 1
    s_cbranch_scc1 L_wait
    s_waitcnt lgkmcnt(0)
    s_barrier
    s_cmp_lg_u32 s3, 0
    s_cbranch_scc1 L_fin
    ds_read_b128 v[202:205], v68 offset:10496
    s_mov_b32 exec_lo, 0xf000f
    s_mov_b32 exec_hi, 0xf000f
    s_waitcnt lgkmcnt(0)
    v_add_f32 v202, v202, v203
    v_add_f32 v204, v204, v205
    v_add_f32 v202, v202, v204
    v_cvt_pk_bf16_f32 v202, v202, v202
    v_lshlrev_b32 v202, 16, v202
    v_add_f32 v202, v202, v64
    v_cvt_pk_bf16_f32 v202, v202, v202
    v_lshlrev_b32 v202, 16, v202
    v_add_f32 v202, v202, v192
    v_cvt_pk_bf16_f32 v202, v202, v202
    buffer_store_short v202, v65, s[40:43], 0 offen
    s_mov_b64 exec, 1
    s_cmp_lg_u32 s2, 0
    s_cbranch_scc1 L_fin
    buffer_store_dword v75, v59, s[44:47], 0 offen
L_fin:
L_done:
    s_endpgm
L_gemv:
    v_perm_b32 v4, v40, v40, v20
    v_perm_b32 v5, v40, v40, v21
    v_perm_b32 v6, v40, v40, v22
    v_perm_b32 v7, v40, v40, v23
    v_perm_b32 v8, v40, v40, v24
    v_perm_b32 v9, v40, v40, v25
    v_perm_b32 v10, v40, v40, v26
    v_perm_b32 v11, v40, v40, v27
    s_waitcnt vmcnt(8)
    v_mfma_f32_16x16x32_bf16 v[36:39], v[4:7], a[0:3], 0
    v_perm_b32 v4, v41, v41, v20
    v_perm_b32 v5, v41, v41, v21
    v_perm_b32 v6, v41, v41, v22
    v_perm_b32 v7, v41, v41, v23
    v_mfma_f32_16x16x32_bf16 v[36:39], v[8:11], a[4:7], v[36:39]
    v_perm_b32 v8, v41, v41, v24
    v_perm_b32 v9, v41, v41, v25
    v_perm_b32 v10, v41, v41, v26
    v_perm_b32 v11, v41, v41, v27
    v_mfma_f32_16x16x32_bf16 v[36:39], v[4:7], a[8:11], v[36:39]
    v_perm_b32 v4, v42, v42, v20
    v_perm_b32 v5, v42, v42, v21
    v_perm_b32 v6, v42, v42, v22
    v_perm_b32 v7, v42, v42, v23
    v_mfma_f32_16x16x32_bf16 v[36:39], v[8:11], a[12:15], v[36:39]
    v_perm_b32 v8, v42, v42, v24
    v_perm_b32 v9, v42, v42, v25
    v_perm_b32 v10, v42, v42, v26
    v_perm_b32 v11, v42, v42, v27
    v_mfma_f32_16x16x32_bf16 v[36:39], v[4:7], a[16:19], v[36:39]
    v_perm_b32 v4, v43, v43, v20
    v_perm_b32 v5, v43, v43, v21
    v_perm_b32 v6, v43, v43, v22
    v_perm_b32 v7, v43, v43, v23
    v_mfma_f32_16x16x32_bf16 v[36:39], v[8:11], a[20:23], v[36:39]
    v_perm_b32 v8, v43, v43, v24
    v_perm_b32 v9, v43, v43, v25
    v_perm_b32 v10, v43, v43, v26
    v_perm_b32 v11, v43, v43, v27
    v_mfma_f32_16x16x32_bf16 v[36:39], v[4:7], a[24:27], v[36:39]
    v_perm_b32 v4, v44, v44, v20
    v_perm_b32 v5, v44, v44, v21
    v_perm_b32 v6, v44, v44, v22
    v_perm_b32 v7, v44, v44, v23
    v_mfma_f32_16x16x32_bf16 v[36:39], v[8:11], a[28:31], v[36:39]
    v_perm_b32 v8, v44, v44, v24
    v_perm_b32 v9, v44, v44, v25
    v_perm_b32 v10, v44, v44, v26
    v_perm_b32 v11, v44, v44, v27
    v_mfma_f32_16x16x32_bf16 v[36:39], v[4:7], a[32:35], v[36:39]
    v_perm_b32 v4, v45, v45, v20
    v_perm_b32 v5, v45, v45, v21
    v_perm_b32 v6, v45, v45, v22
    v_perm_b32 v7, v45, v45, v23
    v_mfma_f32_16x16x32_bf16 v[36:39], v[8:11], a[36:39], v[36:39]
    v_perm_b32 v8, v45, v45, v24
    v_perm_b32 v9, v45, v45, v25
    v_perm_b32 v10, v45, v45, v26
    v_perm_b32 v11, v45, v45, v27
    v_mfma_f32_16x16x32_bf16 v[36:39], v[4:7], a[40:43], v[36:39]
    v_perm_b32 v4, v46, v46, v20
    v_perm_b32 v5, v46, v46, v21
    v_perm_b32 v6, v46, v46, v22
    v_perm_b32 v7, v46, v46, v23
    v_mfma_f32_16x16x32_bf16 v[36:39], v[8:11], a[44:47], v[36:39]
    v_perm_b32 v8, v46, v46, v24
    v_perm_b32 v9, v46, v46, v25
    v_perm_b32 v10, v46, v46, v26
    v_perm_b32 v11, v46, v46, v27
    v_mfma_f32_16x16x32_bf16 v[36:39], v[4:7], a[48:51], v[36:39]
    v_perm_b32 v4, v47, v47, v20
    v_perm_b32 v5, v47, v47, v21
    v_perm_b32 v6, v47, v47, v22
    v_perm_b32 v7, v47, v47, v23
    v_mfma_f32_16x16x32_bf16 v[36:39], v[8:11], a[52:55], v[36:39]
    v_perm_b32 v8, v47, v47, v24
    v_perm_b32 v9, v47, v47, v25
    v_perm_b32 v10, v47, v47, v26
    v_perm_b32 v11, v47, v47, v27
    v_mfma_f32_16x16x32_bf16 v[36:39], v[4:7], a[56:59], v[36:39]
    v_perm_b32 v4, v48, v48, v20
    v_perm_b32 v5, v48, v48, v21
    v_perm_b32 v6, v48, v48, v22
    v_perm_b32 v7, v48, v48, v23
    v_mfma_f32_16x16x32_bf16 v[36:39], v[8:11], a[60:63], v[36:39]
    v_perm_b32 v8, v48, v48, v24
    v_perm_b32 v9, v48, v48, v25
    v_perm_b32 v10, v48, v48, v26
    v_perm_b32 v11, v48, v48, v27
    v_mfma_f32_16x16x32_bf16 v[36:39], v[4:7], a[64:67], v[36:39]
    v_perm_b32 v4, v49, v49, v20
    v_perm_b32 v5, v49, v49, v21
    v_perm_b32 v6, v49, v49, v22
    v_perm_b32 v7, v49, v49, v23
    v_mfma_f32_16x16x32_bf16 v[36:39], v[8:11], a[68:71], v[36:39]
    v_perm_b32 v8, v49, v49, v24
    v_perm_b32 v9, v49, v49, v25
    v_perm_b32 v10, v49, v49, v26
    v_perm_b32 v11, v49, v49, v27
    v_mfma_f32_16x16x32_bf16 v[36:39], v[4:7], a[72:75], v[36:39]
    v_perm_b32 v4, v50, v50, v20
    v_perm_b32 v5, v50, v50, v21
    v_perm_b32 v6, v50, v50, v22
    v_perm_b32 v7, v50, v50, v23
    v_mfma_f32_16x16x32_bf16 v[36:39], v[8:11], a[76:79], v[36:39]
    v_perm_b32 v8, v50, v50, v24
    v_perm_b32 v9, v50, v50, v25
    v_perm_b32 v10, v50, v50, v26
    v_perm_b32 v11, v50, v50, v27
    v_mfma_f32_16x16x32_bf16 v[36:39], v[4:7], a[80:83], v[36:39]
    v_perm_b32 v4, v51, v51, v20
    v_perm_b32 v5, v51, v51, v21
    v_perm_b32 v6, v51, v51, v22
    v_perm_b32 v7, v51, v51, v23
    v_mfma_f32_16x16x32_bf16 v[36:39], v[8:11], a[84:87], v[36:39]
    v_perm_b32 v8, v51, v51, v24
    v_perm_b32 v9, v51, v51, v25
    v_perm_b32 v10, v51, v51, v26
    v_perm_b32 v11, v51, v51, v27
    v_mfma_f32_16x16x32_bf16 v[36:39], v[4:7], a[88:91], v[36:39]
    v_perm_b32 v4, v52, v52, v20
    v_perm_b32 v5, v52, v52, v21
    v_perm_b32 v6, v52, v52, v22
    v_perm_b32 v7, v52, v52, v23
    v_mfma_f32_16x16x32_bf16 v[36:39], v[8:11], a[92:95], v[36:39]
    v_perm_b32 v8, v52, v52, v24
    v_perm_b32 v9, v52, v52, v25
    v_perm_b32 v10, v52, v52, v26
    v_perm_b32 v11, v52, v52, v27
    v_mfma_f32_16x16x32_bf16 v[36:39], v[4:7], a[96:99], v[36:39]
    v_perm_b32 v4, v53, v53, v20
    v_perm_b32 v5, v53, v53, v21
    v_perm_b32 v6, v53, v53, v22
    v_perm_b32 v7, v53, v53, v23
    v_mfma_f32_16x16x32_bf16 v[36:39], v[8:11], a[100:103], v[36:39]
    v_perm_b32 v8, v53, v53, v24
    v_perm_b32 v9, v53, v53, v25
    v_perm_b32 v10, v53, v53, v26
    v_perm_b32 v11, v53, v53, v27
    v_mfma_f32_16x16x32_bf16 v[36:39], v[4:7], a[104:107], v[36:39]
    v_perm_b32 v4, v54, v54, v20
    v_perm_b32 v5, v54, v54, v21
    v_perm_b32 v6, v54, v54, v22
    v_perm_b32 v7, v54, v54, v23
    v_mfma_f32_16x16x32_bf16 v[36:39], v[8:11], a[108:111], v[36:39]
    v_perm_b32 v8, v54, v54, v24
    v_perm_b32 v9, v54, v54, v25
    v_perm_b32 v10, v54, v54, v26
    v_perm_b32 v11, v54, v54, v27
    s_waitcnt vmcnt(6)
    v_mfma_f32_16x16x32_bf16 v[36:39], v[4:7], a[112:115], v[36:39]
    v_perm_b32 v4, v55, v55, v20
    v_perm_b32 v5, v55, v55, v21
    v_perm_b32 v6, v55, v55, v22
    v_perm_b32 v7, v55, v55, v23
    s_waitcnt vmcnt(4)
    v_mfma_f32_16x16x32_bf16 v[36:39], v[8:11], a[116:119], v[36:39]
    v_perm_b32 v8, v55, v55, v24
    v_perm_b32 v9, v55, v55, v25
    v_perm_b32 v10, v55, v55, v26
    v_perm_b32 v11, v55, v55, v27
    s_waitcnt vmcnt(3)
    v_mfma_f32_16x16x32_bf16 v[36:39], v[4:7], a[120:123], v[36:39]
    s_waitcnt vmcnt(1)
    v_mfma_f32_16x16x32_bf16 v[36:39], v[8:11], a[124:127], v[36:39]
    v_mov_b32 v4, 0
    v_mov_b32 v5, 0
    v_mov_b32 v6, 0
    v_mov_b32 v7, 0
    s_nop 3
    s_setpc_b64 s[48:49]
.section .rodata,"a"
.p2align 6
.amdhsa_kernel parallel_sum__mha_block_cached__mixer_token_mlp__decode_kernel
  .amdhsa_next_free_vgpr 384
  .amdhsa_next_free_sgpr 102
  .amdhsa_accum_offset 256
  .amdhsa_group_segment_fixed_size 0
  .amdhsa_kernarg_size 104
  .amdhsa_user_sgpr_count 2
  .amdhsa_user_sgpr_kernarg_segment_ptr 1
  .amdhsa_system_sgpr_workgroup_id_x 1
  .amdhsa_float_denorm_mode_32 3
.end_amdhsa_kernel
```
